```python
import torch

def _softmax(x, axis=-1):
    return torch.softmax(x, dim=axis)
def _gelu(x):
    return torch.nn.functional.gelu(x, approximate="tanh")
def _silu(x):
    return torch.nn.functional.silu(x)
def _sigmoid(x):
    return torch.sigmoid(x)
def _layernorm(x, axis=-1, eps=1e-5):
    m = x.mean(dim=axis, keepdim=True)
    v = x.var(dim=axis, keepdim=True, unbiased=False)
    return (x - m) / torch.sqrt(v + eps)
def _scatter_add(tgt, idx, src, axis=0):
    return tgt.clone().index_add_(axis, idx, src)
def _segment_sum(src, seg, n):
    out = torch.zeros((n,) + src.shape[1:], dtype=src.dtype)
    return out.index_add_(0, seg, src)
def _pad(x, pw):
    flat = tuple(v for pair in reversed(pw) for v in pair)
    return torch.nn.functional.pad(x, flat)

kernel_name = 'gated_mix__mha_block__ssm_conv_s4d__prompt'

def setup_inputs():

    _w = (lambda a: (lambda t: t.to(torch.bfloat16) if t.is_floating_point() else t)(torch.as_tensor(a)))
    def _A_setup():
        B, S, D, H = 1, 2048, 576, 32
        return {
            "x": _w((lambda *s: torch.randn(*s, dtype=torch.bfloat16) * 0.05)(B, S, D)),
            "wqkv": _w((lambda *s: torch.randn(*s, dtype=torch.bfloat16) * 0.8)(D, 3 * D)),
            "wo": _w((lambda *s: torch.randn(*s, dtype=torch.bfloat16) * 0.05)(D, D)),
        }
    _A_in = _A_setup()

    def _B_setup():
        Bsz, L, D, N = 1, 2048, 576, 128
        return {
            "u": _w((lambda *s: torch.randn(*s, dtype=torch.bfloat16) * 0.05)(Bsz, L, D)),
            "log_A_real": _w((lambda *s: torch.randn(*s, dtype=torch.bfloat16) * 6.4)(D, N) * 0.5),
            "A_imag": _w((lambda *s: torch.randn(*s, dtype=torch.bfloat16) * 0.1)(D, N) * 3.14),
            "C_real": _w((lambda *s: torch.randn(*s, dtype=torch.bfloat16) * 0.4)(D, N) / N ** 0.5),
            "C_imag": _w((lambda *s: torch.randn(*s, dtype=torch.bfloat16) * 0.4)(D, N) / N ** 0.5),
            "log_dt": _w((lambda *s: torch.randn(*s, dtype=torch.bfloat16) * 0.1)(D) * 0.5 - 4.0),
            "D_skip": _w((lambda *s: torch.randn(*s, dtype=torch.bfloat16) * 0.1)(D)),
        }
    _B_in = _B_setup()

    return {
        "A_x": _A_in["x"],
        "A_wqkv": _A_in["wqkv"],
        "A_wo": _A_in["wo"],
        "B_u": _B_in["u"],
        "B_log_A_real": _B_in["log_A_real"],
        "B_A_imag": _B_in["A_imag"],
        "B_C_real": _B_in["C_real"],
        "B_C_imag": _B_in["C_imag"],
        "B_log_dt": _B_in["log_dt"],
        "B_D_skip": _B_in["D_skip"],
        "gate_w": _w((lambda *s: torch.randn(*s, dtype=torch.bfloat16) * 0.05)(576) * 16.0),
    }

def reference(A_x, A_wqkv, A_wo, B_u, B_log_A_real, B_A_imag, B_C_real, B_C_imag, B_log_dt, B_D_skip, gate_w):
    def _A_ref(x, wqkv, wo):
        B, S, D = x.shape
        H = 32
        Dh = D // H
        qkv = (lambda x, *d: x.permute(*d))((x @ wqkv).reshape(B, S, 3, H, Dh), 2, 0, 3, 1, 4)
        q, k, v = qkv[0], qkv[1], qkv[2]
        scores = torch.einsum("bhqd,bhkd->bhqk", q, k) * (Dh ** -0.5)
        p = _softmax(scores, axis=-1)
        o = torch.einsum("bhqk,bhkd->bhqd", p, v)
        return (lambda x, *d: x.permute(*d))(o, 0, 2, 1, 3).reshape(B, S, D) @ wo

    def _B_ref(u, log_A_real, A_imag, C_real, C_imag, log_dt, D_skip):
        L = u.shape[1]
        dt = torch.exp(log_dt)
        A = -torch.exp(log_A_real) + 1j * A_imag
        C = (C_real + 1j * C_imag) * dt[:, None]
        pos = (lambda x, dt: x.to(dt))(torch.arange(L), log_dt.dtype)
        P = torch.exp((A * dt[:, None])[:, :, None] * pos[None, None, :])
        K = 2.0 * torch.einsum("dn,dnl->dl", C, P).real
        L2 = 2 * L
        u_t = (lambda x, *d: x.permute(*d))(u, 0, 2, 1)
        Kf = (lambda x, *a, **k: torch.fft.rfft(x.float(), *a, **k))(K, L2)
        Uf = (lambda x, *a, **k: torch.fft.rfft(x.float(), *a, **k))(u_t, L2)
        y = (lambda x, *a, **k: torch.fft.irfft(x, *a, **k).to(torch.bfloat16))(Uf * Kf[None, :, :], L2)[:, :, :L]
        y = (lambda x, *d: x.permute(*d))(y, 0, 2, 1)
        return y + u * D_skip[None, None, :]

    x = A_x
    g = _sigmoid((x * gate_w).sum(-1, keepdims=True))
    a = _A_ref(x, A_wqkv, A_wo)
    b = _B_ref(x, B_log_A_real, B_A_imag, B_C_real, B_C_imag, B_log_dt, B_D_skip)
    return g * a + (1 - g) * b
```

```asm
; @launch kernel=l1_kernel grid=(480,1,1) block=(256,1,1) lds=61440
; @launch kernel=l2_kernel grid=(408,1,1) block=(256,1,1) lds=60992
; @launch kernel=l3_kernel grid=(288,1,1) block=(256,1,1) lds=64512
.amdgcn_target "amdgcn-amd-amdhsa--gfx950"
.text
.globl l1_kernel
.p2align 8
.type l1_kernel,@function
l1_kernel:
    s_cmp_ge_u32 s2, 240
    s_cbranch_scc1 PREP_2
    s_load_dwordx4 s[20:23], s[0:1], 0
    s_load_dwordx2 s[24:25], s[0:1], 104
    s_waitcnt lgkmcnt(0)
    s_mov_b32 s4, s20
    s_mov_b32 s5, s21
    s_mov_b32 s6, 0x240000
    s_mov_b32 s7, 0x00020000
    s_mov_b32 s8, s22
    s_mov_b32 s9, s23
    s_mov_b32 s10, 0x1e6000
    s_mov_b32 s11, 0x00020000
    s_mov_b32 s12, s24
    s_mov_b32 s13, s25
    s_mov_b32 s14, 0x6c0000
    s_mov_b32 s15, 0x00020000
    s_cmp_ge_u32 s2, 144
    s_cbranch_scc1 VPART_4
    s_and_b32 s26, s2, 15
    s_lshl_b32 s26, s26, 7
    s_lshr_b32 s27, s2, 4
    s_lshl_b32 s27, s27, 7
    v_lshrrev_b32 v11, 2, v0
    v_and_b32 v12, 3, v0
    v_lshlrev_b32 v12, 4, v12
    v_mul_u32_u24 v3, 80, v11
    v_add_u32 v3, v3, v12
    v_add_u32 v11, s26, v11
    v_mul_u32_u24 v1, 1152, v11
    v_add_u32 v1, v1, v12
    v_lshrrev_b32 v11, 2, v0
    v_add_u32 v11, 64, v11
    v_and_b32 v12, 3, v0
    v_lshlrev_b32 v12, 4, v12
    v_mul_u32_u24 v4, 80, v11
    v_add_u32 v4, v4, v12
    v_add_u32 v11, s26, v11
    v_mul_u32_u24 v2, 1152, v11
    v_add_u32 v2, v2, v12
    v_add_u32 v13, 0, v0
    v_lshrrev_b32 v11, 4, v13
    v_and_b32 v12, 15, v13
    v_lshlrev_b32 v12, 4, v12
    v_mul_u32_u24 v7, 320, v11
    v_add_u32 v7, v7, v12
    v_mul_u32_u24 v5, 3456, v11
    v_add_u32 v5, v5, v12
    v_add_u32 v5, s27, v5
    v_add_u32 v5, s27, v5
    v_add_u32 v13, 256, v0
    v_lshrrev_b32 v11, 4, v13
    v_and_b32 v12, 15, v13
    v_lshlrev_b32 v12, 4, v12
    v_mul_u32_u24 v8, 320, v11
    v_add_u32 v8, v8, v12
    v_mul_u32_u24 v6, 3456, v11
    v_add_u32 v6, v6, v12
    v_add_u32 v6, s27, v6
    v_add_u32 v6, s27, v6
    v_lshrrev_b32 v11, 6, v0
    v_lshrrev_b32 v12, 1, v11
    v_and_b32 v11, 1, v11
    v_mul_u32_u24 v12, 64, v12
    v_and_b32 v13, 31, v0
    v_add_u32 v12, v12, v13
    v_mul_u32_u24 v9, 80, v12
    v_bfe_u32 v13, v0, 5, 1
    v_lshl_add_u32 v9, v13, 4, v9
    v_bfe_u32 v12, v0, 2, 2
    v_lshl_add_u32 v12, v13, 3, v12
    v_mul_u32_u24 v10, 320, v12
    v_mul_u32_u24 v11, 128, v11
    v_add_u32 v10, v10, v11
    v_bfe_u32 v11, v0, 4, 1
    v_lshl_add_u32 v10, v11, 5, v10
    v_and_b32 v11, 3, v0
    v_lshl_add_u32 v10, v11, 3, v10
    v_add_u32 v10, 10240, v10
    buffer_load_dwordx4 v[112:115], v1, s[4:7], 0 offen offset:0
    buffer_load_dwordx4 v[116:119], v2, s[4:7], 0 offen offset:0
    s_mov_b32 s28, 0x0
    buffer_load_dwordx4 v[120:123], v5, s[8:11], s28 offen
    buffer_load_dwordx4 v[124:127], v6, s[8:11], s28 offen
    buffer_load_dwordx4 v[128:131], v1, s[4:7], 0 offen offset:64
    buffer_load_dwordx4 v[132:135], v2, s[4:7], 0 offen offset:64
    s_mov_b32 s28, 0x1b000
    buffer_load_dwordx4 v[136:139], v5, s[8:11], s28 offen
    buffer_load_dwordx4 v[140:143], v6, s[8:11], s28 offen
    buffer_load_dwordx4 v[144:147], v1, s[4:7], 0 offen offset:128
    buffer_load_dwordx4 v[148:151], v2, s[4:7], 0 offen offset:128
    s_mov_b32 s28, 0x36000
    buffer_load_dwordx4 v[152:155], v5, s[8:11], s28 offen
    buffer_load_dwordx4 v[156:159], v6, s[8:11], s28 offen
    buffer_load_dwordx4 v[160:163], v1, s[4:7], 0 offen offset:192
    buffer_load_dwordx4 v[164:167], v2, s[4:7], 0 offen offset:192
    s_mov_b32 s28, 0x51000
    buffer_load_dwordx4 v[168:171], v5, s[8:11], s28 offen
    buffer_load_dwordx4 v[172:175], v6, s[8:11], s28 offen
    s_waitcnt vmcnt(12)
    ds_write_b128 v3, v[112:115] offset:0
    ds_write_b128 v4, v[116:119] offset:0
    ds_write_b128 v7, v[120:123] offset:10240
    ds_write_b128 v8, v[124:127] offset:10240
    buffer_load_dwordx4 v[112:115], v1, s[4:7], 0 offen offset:256
    buffer_load_dwordx4 v[116:119], v2, s[4:7], 0 offen offset:256
    s_mov_b32 s28, 0x6c000
    buffer_load_dwordx4 v[120:123], v5, s[8:11], s28 offen
    buffer_load_dwordx4 v[124:127], v6, s[8:11], s28 offen
    s_waitcnt lgkmcnt(0)
    s_barrier
    ds_read_b128 v[16:19], v9 offset:0
    ds_read_b128 v[20:23], v9 offset:2560
    ds_read_b64_tr_b16 v[32:33], v10 offset:0
    ds_read_b64_tr_b16 v[34:35], v10 offset:1280
    ds_read_b64_tr_b16 v[36:37], v10 offset:64
    ds_read_b64_tr_b16 v[38:39], v10 offset:1344
    s_waitcnt vmcnt(12)
    ds_write_b128 v3, v[128:131] offset:20480
    ds_write_b128 v4, v[132:135] offset:20480
    ds_write_b128 v7, v[136:139] offset:30720
    ds_write_b128 v8, v[140:143] offset:30720
    buffer_load_dwordx4 v[128:131], v1, s[4:7], 0 offen offset:320
    buffer_load_dwordx4 v[132:135], v2, s[4:7], 0 offen offset:320
    s_mov_b32 s28, 0x87000
    buffer_load_dwordx4 v[136:139], v5, s[8:11], s28 offen
    buffer_load_dwordx4 v[140:143], v6, s[8:11], s28 offen
    ds_read_b128 v[24:27], v9 offset:32
    ds_read_b128 v[28:31], v9 offset:2592
    ds_read_b64_tr_b16 v[40:41], v10 offset:5120
    ds_read_b64_tr_b16 v[42:43], v10 offset:6400
    ds_read_b64_tr_b16 v[44:45], v10 offset:5184
    ds_read_b64_tr_b16 v[46:47], v10 offset:6464
    s_waitcnt lgkmcnt(10)
    v_mfma_f32_32x32x16_bf16 v[48:63], v[16:19], v[32:35], 0
    v_mfma_f32_32x32x16_bf16 v[64:79], v[16:19], v[36:39], 0
    v_mfma_f32_32x32x16_bf16 v[80:95], v[20:23], v[32:35], 0
    v_mfma_f32_32x32x16_bf16 v[96:111], v[20:23], v[36:39], 0
    s_waitcnt lgkmcnt(0)
    s_barrier
    ds_read_b128 v[16:19], v9 offset:20480
    ds_read_b128 v[20:23], v9 offset:23040
    ds_read_b64_tr_b16 v[32:33], v10 offset:20480
    ds_read_b64_tr_b16 v[34:35], v10 offset:21760
    ds_read_b64_tr_b16 v[36:37], v10 offset:20544
    ds_read_b64_tr_b16 v[38:39], v10 offset:21824
    v_mfma_f32_32x32x16_bf16 v[48:63], v[24:27], v[40:43], v[48:63]
    v_mfma_f32_32x32x16_bf16 v[64:79], v[24:27], v[44:47], v[64:79]
    v_mfma_f32_32x32x16_bf16 v[80:95], v[28:31], v[40:43], v[80:95]
    v_mfma_f32_32x32x16_bf16 v[96:111], v[28:31], v[44:47], v[96:111]
    s_waitcnt vmcnt(12)
    ds_write_b128 v3, v[144:147] offset:40960
    ds_write_b128 v4, v[148:151] offset:40960
    ds_write_b128 v7, v[152:155] offset:51200
    ds_write_b128 v8, v[156:159] offset:51200
    buffer_load_dwordx4 v[144:147], v1, s[4:7], 0 offen offset:384
    buffer_load_dwordx4 v[148:151], v2, s[4:7], 0 offen offset:384
    s_mov_b32 s28, 0xa2000
    buffer_load_dwordx4 v[152:155], v5, s[8:11], s28 offen
    buffer_load_dwordx4 v[156:159], v6, s[8:11], s28 offen
    ds_read_b128 v[24:27], v9 offset:20512
    ds_read_b128 v[28:31], v9 offset:23072
    ds_read_b64_tr_b16 v[40:41], v10 offset:25600
    ds_read_b64_tr_b16 v[42:43], v10 offset:26880
    ds_read_b64_tr_b16 v[44:45], v10 offset:25664
    ds_read_b64_tr_b16 v[46:47], v10 offset:26944
    s_waitcnt lgkmcnt(10)
    v_mfma_f32_32x32x16_bf16 v[48:63], v[16:19], v[32:35], v[48:63]
    v_mfma_f32_32x32x16_bf16 v[64:79], v[16:19], v[36:39], v[64:79]
    v_mfma_f32_32x32x16_bf16 v[80:95], v[20:23], v[32:35], v[80:95]
    v_mfma_f32_32x32x16_bf16 v[96:111], v[20:23], v[36:39], v[96:111]
    s_waitcnt lgkmcnt(0)
    s_barrier
    ds_read_b128 v[16:19], v9 offset:40960
    ds_read_b128 v[20:23], v9 offset:43520
    ds_read_b64_tr_b16 v[32:33], v10 offset:40960
    ds_read_b64_tr_b16 v[34:35], v10 offset:42240
    ds_read_b64_tr_b16 v[36:37], v10 offset:41024
    ds_read_b64_tr_b16 v[38:39], v10 offset:42304
    v_mfma_f32_32x32x16_bf16 v[48:63], v[24:27], v[40:43], v[48:63]
    v_mfma_f32_32x32x16_bf16 v[64:79], v[24:27], v[44:47], v[64:79]
    v_mfma_f32_32x32x16_bf16 v[80:95], v[28:31], v[40:43], v[80:95]
    v_mfma_f32_32x32x16_bf16 v[96:111], v[28:31], v[44:47], v[96:111]
    s_waitcnt vmcnt(12)
    ds_write_b128 v3, v[160:163] offset:0
    ds_write_b128 v4, v[164:167] offset:0
    ds_write_b128 v7, v[168:171] offset:10240
    ds_write_b128 v8, v[172:175] offset:10240
    buffer_load_dwordx4 v[160:163], v1, s[4:7], 0 offen offset:448
    buffer_load_dwordx4 v[164:167], v2, s[4:7], 0 offen offset:448
    s_mov_b32 s28, 0xbd000
    buffer_load_dwordx4 v[168:171], v5, s[8:11], s28 offen
    buffer_load_dwordx4 v[172:175], v6, s[8:11], s28 offen
    ds_read_b128 v[24:27], v9 offset:40992
    ds_read_b128 v[28:31], v9 offset:43552
    ds_read_b64_tr_b16 v[40:41], v10 offset:46080
    ds_read_b64_tr_b16 v[42:43], v10 offset:47360
    ds_read_b64_tr_b16 v[44:45], v10 offset:46144
    ds_read_b64_tr_b16 v[46:47], v10 offset:47424
    s_waitcnt lgkmcnt(10)
    v_mfma_f32_32x32x16_bf16 v[48:63], v[16:19], v[32:35], v[48:63]
    v_mfma_f32_32x32x16_bf16 v[64:79], v[16:19], v[36:39], v[64:79]
    v_mfma_f32_32x32x16_bf16 v[80:95], v[20:23], v[32:35], v[80:95]
    v_mfma_f32_32x32x16_bf16 v[96:111], v[20:23], v[36:39], v[96:111]
    s_waitcnt lgkmcnt(0)
    s_barrier
    ds_read_b128 v[16:19], v9 offset:0
    ds_read_b128 v[20:23], v9 offset:2560
    ds_read_b64_tr_b16 v[32:33], v10 offset:0
    ds_read_b64_tr_b16 v[34:35], v10 offset:1280
    ds_read_b64_tr_b16 v[36:37], v10 offset:64
    ds_read_b64_tr_b16 v[38:39], v10 offset:1344
    v_mfma_f32_32x32x16_bf16 v[48:63], v[24:27], v[40:43], v[48:63]
    v_mfma_f32_32x32x16_bf16 v[64:79], v[24:27], v[44:47], v[64:79]
    v_mfma_f32_32x32x16_bf16 v[80:95], v[28:31], v[40:43], v[80:95]
    v_mfma_f32_32x32x16_bf16 v[96:111], v[28:31], v[44:47], v[96:111]
    s_waitcnt vmcnt(12)
    ds_write_b128 v3, v[112:115] offset:20480
    ds_write_b128 v4, v[116:119] offset:20480
    ds_write_b128 v7, v[120:123] offset:30720
    ds_write_b128 v8, v[124:127] offset:30720
    buffer_load_dwordx4 v[112:115], v1, s[4:7], 0 offen offset:512
    buffer_load_dwordx4 v[116:119], v2, s[4:7], 0 offen offset:512
    s_mov_b32 s28, 0xd8000
    buffer_load_dwordx4 v[120:123], v5, s[8:11], s28 offen
    buffer_load_dwordx4 v[124:127], v6, s[8:11], s28 offen
    ds_read_b128 v[24:27], v9 offset:32
    ds_read_b128 v[28:31], v9 offset:2592
    ds_read_b64_tr_b16 v[40:41], v10 offset:5120
    ds_read_b64_tr_b16 v[42:43], v10 offset:6400
    ds_read_b64_tr_b16 v[44:45], v10 offset:5184
    ds_read_b64_tr_b16 v[46:47], v10 offset:6464
    s_waitcnt lgkmcnt(10)
    v_mfma_f32_32x32x16_bf16 v[48:63], v[16:19], v[32:35], v[48:63]
    v_mfma_f32_32x32x16_bf16 v[64:79], v[16:19], v[36:39], v[64:79]
    v_mfma_f32_32x32x16_bf16 v[80:95], v[20:23], v[32:35], v[80:95]
    v_mfma_f32_32x32x16_bf16 v[96:111], v[20:23], v[36:39], v[96:111]
    s_waitcnt lgkmcnt(0)
    s_barrier
    ds_read_b128 v[16:19], v9 offset:20480
    ds_read_b128 v[20:23], v9 offset:23040
    ds_read_b64_tr_b16 v[32:33], v10 offset:20480
    ds_read_b64_tr_b16 v[34:35], v10 offset:21760
    ds_read_b64_tr_b16 v[36:37], v10 offset:20544
    ds_read_b64_tr_b16 v[38:39], v10 offset:21824
    v_mfma_f32_32x32x16_bf16 v[48:63], v[24:27], v[40:43], v[48:63]
    v_mfma_f32_32x32x16_bf16 v[64:79], v[24:27], v[44:47], v[64:79]
    v_mfma_f32_32x32x16_bf16 v[80:95], v[28:31], v[40:43], v[80:95]
    v_mfma_f32_32x32x16_bf16 v[96:111], v[28:31], v[44:47], v[96:111]
    s_waitcnt vmcnt(12)
    ds_write_b128 v3, v[128:131] offset:40960
    ds_write_b128 v4, v[132:135] offset:40960
    ds_write_b128 v7, v[136:139] offset:51200
    ds_write_b128 v8, v[140:143] offset:51200
    buffer_load_dwordx4 v[128:131], v1, s[4:7], 0 offen offset:576
    buffer_load_dwordx4 v[132:135], v2, s[4:7], 0 offen offset:576
    s_mov_b32 s28, 0xf3000
    buffer_load_dwordx4 v[136:139], v5, s[8:11], s28 offen
    buffer_load_dwordx4 v[140:143], v6, s[8:11], s28 offen
    ds_read_b128 v[24:27], v9 offset:20512
    ds_read_b128 v[28:31], v9 offset:23072
    ds_read_b64_tr_b16 v[40:41], v10 offset:25600
    ds_read_b64_tr_b16 v[42:43], v10 offset:26880
    ds_read_b64_tr_b16 v[44:45], v10 offset:25664
    ds_read_b64_tr_b16 v[46:47], v10 offset:26944
    s_waitcnt lgkmcnt(10)
    v_mfma_f32_32x32x16_bf16 v[48:63], v[16:19], v[32:35], v[48:63]
    v_mfma_f32_32x32x16_bf16 v[64:79], v[16:19], v[36:39], v[64:79]
    v_mfma_f32_32x32x16_bf16 v[80:95], v[20:23], v[32:35], v[80:95]
    v_mfma_f32_32x32x16_bf16 v[96:111], v[20:23], v[36:39], v[96:111]
    s_waitcnt lgkmcnt(0)
    s_barrier
    ds_read_b128 v[16:19], v9 offset:40960
    ds_read_b128 v[20:23], v9 offset:43520
    ds_read_b64_tr_b16 v[32:33], v10 offset:40960
    ds_read_b64_tr_b16 v[34:35], v10 offset:42240
    ds_read_b64_tr_b16 v[36:37], v10 offset:41024
    ds_read_b64_tr_b16 v[38:39], v10 offset:42304
    v_mfma_f32_32x32x16_bf16 v[48:63], v[24:27], v[40:43], v[48:63]
    v_mfma_f32_32x32x16_bf16 v[64:79], v[24:27], v[44:47], v[64:79]
    v_mfma_f32_32x32x16_bf16 v[80:95], v[28:31], v[40:43], v[80:95]
    v_mfma_f32_32x32x16_bf16 v[96:111], v[28:31], v[44:47], v[96:111]
    s_waitcnt vmcnt(12)
    ds_write_b128 v3, v[144:147] offset:0
    ds_write_b128 v4, v[148:151] offset:0
    ds_write_b128 v7, v[152:155] offset:10240
    ds_write_b128 v8, v[156:159] offset:10240
    buffer_load_dwordx4 v[144:147], v1, s[4:7], 0 offen offset:640
    buffer_load_dwordx4 v[148:151], v2, s[4:7], 0 offen offset:640
    s_mov_b32 s28, 0x10e000
    buffer_load_dwordx4 v[152:155], v5, s[8:11], s28 offen
    buffer_load_dwordx4 v[156:159], v6, s[8:11], s28 offen
    ds_read_b128 v[24:27], v9 offset:40992
    ds_read_b128 v[28:31], v9 offset:43552
    ds_read_b64_tr_b16 v[40:41], v10 offset:46080
    ds_read_b64_tr_b16 v[42:43], v10 offset:47360
    ds_read_b64_tr_b16 v[44:45], v10 offset:46144
    ds_read_b64_tr_b16 v[46:47], v10 offset:47424
    s_waitcnt lgkmcnt(10)
    v_mfma_f32_32x32x16_bf16 v[48:63], v[16:19], v[32:35], v[48:63]
    v_mfma_f32_32x32x16_bf16 v[64:79], v[16:19], v[36:39], v[64:79]
    v_mfma_f32_32x32x16_bf16 v[80:95], v[20:23], v[32:35], v[80:95]
    v_mfma_f32_32x32x16_bf16 v[96:111], v[20:23], v[36:39], v[96:111]
    s_waitcnt lgkmcnt(0)
    s_barrier
    ds_read_b128 v[16:19], v9 offset:0
    ds_read_b128 v[20:23], v9 offset:2560
    ds_read_b64_tr_b16 v[32:33], v10 offset:0
    ds_read_b64_tr_b16 v[34:35], v10 offset:1280
    ds_read_b64_tr_b16 v[36:37], v10 offset:64
    ds_read_b64_tr_b16 v[38:39], v10 offset:1344
    v_mfma_f32_32x32x16_bf16 v[48:63], v[24:27], v[40:43], v[48:63]
    v_mfma_f32_32x32x16_bf16 v[64:79], v[24:27], v[44:47], v[64:79]
    v_mfma_f32_32x32x16_bf16 v[80:95], v[28:31], v[40:43], v[80:95]
    v_mfma_f32_32x32x16_bf16 v[96:111], v[28:31], v[44:47], v[96:111]
    s_waitcnt vmcnt(12)
    ds_write_b128 v3, v[160:163] offset:20480
    ds_write_b128 v4, v[164:167] offset:20480
    ds_write_b128 v7, v[168:171] offset:30720
    ds_write_b128 v8, v[172:175] offset:30720
    buffer_load_dwordx4 v[160:163], v1, s[4:7], 0 offen offset:704
    buffer_load_dwordx4 v[164:167], v2, s[4:7], 0 offen offset:704
    s_mov_b32 s28, 0x129000
    buffer_load_dwordx4 v[168:171], v5, s[8:11], s28 offen
    buffer_load_dwordx4 v[172:175], v6, s[8:11], s28 offen
    ds_read_b128 v[24:27], v9 offset:32
    ds_read_b128 v[28:31], v9 offset:2592
    ds_read_b64_tr_b16 v[40:41], v10 offset:5120
    ds_read_b64_tr_b16 v[42:43], v10 offset:6400
    ds_read_b64_tr_b16 v[44:45], v10 offset:5184
    ds_read_b64_tr_b16 v[46:47], v10 offset:6464
    s_waitcnt lgkmcnt(10)
    v_mfma_f32_32x32x16_bf16 v[48:63], v[16:19], v[32:35], v[48:63]
    v_mfma_f32_32x32x16_bf16 v[64:79], v[16:19], v[36:39], v[64:79]
    v_mfma_f32_32x32x16_bf16 v[80:95], v[20:23], v[32:35], v[80:95]
    v_mfma_f32_32x32x16_bf16 v[96:111], v[20:23], v[36:39], v[96:111]
    s_waitcnt lgkmcnt(0)
    s_barrier
    ds_read_b128 v[16:19], v9 offset:20480
    ds_read_b128 v[20:23], v9 offset:23040
    ds_read_b64_tr_b16 v[32:33], v10 offset:20480
    ds_read_b64_tr_b16 v[34:35], v10 offset:21760
    ds_read_b64_tr_b16 v[36:37], v10 offset:20544
    ds_read_b64_tr_b16 v[38:39], v10 offset:21824
    v_mfma_f32_32x32x16_bf16 v[48:63], v[24:27], v[40:43], v[48:63]
    v_mfma_f32_32x32x16_bf16 v[64:79], v[24:27], v[44:47], v[64:79]
    v_mfma_f32_32x32x16_bf16 v[80:95], v[28:31], v[40:43], v[80:95]
    v_mfma_f32_32x32x16_bf16 v[96:111], v[28:31], v[44:47], v[96:111]
    s_waitcnt vmcnt(12)
    ds_write_b128 v3, v[112:115] offset:40960
    ds_write_b128 v4, v[116:119] offset:40960
    ds_write_b128 v7, v[120:123] offset:51200
    ds_write_b128 v8, v[124:127] offset:51200
    buffer_load_dwordx4 v[112:115], v1, s[4:7], 0 offen offset:768
    buffer_load_dwordx4 v[116:119], v2, s[4:7], 0 offen offset:768
    s_mov_b32 s28, 0x144000
    buffer_load_dwordx4 v[120:123], v5, s[8:11], s28 offen
    buffer_load_dwordx4 v[124:127], v6, s[8:11], s28 offen
    ds_read_b128 v[24:27], v9 offset:20512
    ds_read_b128 v[28:31], v9 offset:23072
    ds_read_b64_tr_b16 v[40:41], v10 offset:25600
    ds_read_b64_tr_b16 v[42:43], v10 offset:26880
    ds_read_b64_tr_b16 v[44:45], v10 offset:25664
    ds_read_b64_tr_b16 v[46:47], v10 offset:26944
    s_waitcnt lgkmcnt(10)
    v_mfma_f32_32x32x16_bf16 v[48:63], v[16:19], v[32:35], v[48:63]
    v_mfma_f32_32x32x16_bf16 v[64:79], v[16:19], v[36:39], v[64:79]
    v_mfma_f32_32x32x16_bf16 v[80:95], v[20:23], v[32:35], v[80:95]
    v_mfma_f32_32x32x16_bf16 v[96:111], v[20:23], v[36:39], v[96:111]
    s_waitcnt lgkmcnt(0)
    s_barrier
    ds_read_b128 v[16:19], v9 offset:40960
    ds_read_b128 v[20:23], v9 offset:43520
    ds_read_b64_tr_b16 v[32:33], v10 offset:40960
    ds_read_b64_tr_b16 v[34:35], v10 offset:42240
    ds_read_b64_tr_b16 v[36:37], v10 offset:41024
    ds_read_b64_tr_b16 v[38:39], v10 offset:42304
    v_mfma_f32_32x32x16_bf16 v[48:63], v[24:27], v[40:43], v[48:63]
    v_mfma_f32_32x32x16_bf16 v[64:79], v[24:27], v[44:47], v[64:79]
    v_mfma_f32_32x32x16_bf16 v[80:95], v[28:31], v[40:43], v[80:95]
    v_mfma_f32_32x32x16_bf16 v[96:111], v[28:31], v[44:47], v[96:111]
    s_waitcnt vmcnt(12)
    ds_write_b128 v3, v[128:131] offset:0
    ds_write_b128 v4, v[132:135] offset:0
    ds_write_b128 v7, v[136:139] offset:10240
    ds_write_b128 v8, v[140:143] offset:10240
    buffer_load_dwordx4 v[128:131], v1, s[4:7], 0 offen offset:832
    buffer_load_dwordx4 v[132:135], v2, s[4:7], 0 offen offset:832
    s_mov_b32 s28, 0x15f000
    buffer_load_dwordx4 v[136:139], v5, s[8:11], s28 offen
    buffer_load_dwordx4 v[140:143], v6, s[8:11], s28 offen
    ds_read_b128 v[24:27], v9 offset:40992
    ds_read_b128 v[28:31], v9 offset:43552
    ds_read_b64_tr_b16 v[40:41], v10 offset:46080
    ds_read_b64_tr_b16 v[42:43], v10 offset:47360
    ds_read_b64_tr_b16 v[44:45], v10 offset:46144
    ds_read_b64_tr_b16 v[46:47], v10 offset:47424
    s_waitcnt lgkmcnt(10)
    v_mfma_f32_32x32x16_bf16 v[48:63], v[16:19], v[32:35], v[48:63]
    v_mfma_f32_32x32x16_bf16 v[64:79], v[16:19], v[36:39], v[64:79]
    v_mfma_f32_32x32x16_bf16 v[80:95], v[20:23], v[32:35], v[80:95]
    v_mfma_f32_32x32x16_bf16 v[96:111], v[20:23], v[36:39], v[96:111]
    s_waitcnt lgkmcnt(0)
    s_barrier
    ds_read_b128 v[16:19], v9 offset:0
    ds_read_b128 v[20:23], v9 offset:2560
    ds_read_b64_tr_b16 v[32:33], v10 offset:0
    ds_read_b64_tr_b16 v[34:35], v10 offset:1280
    ds_read_b64_tr_b16 v[36:37], v10 offset:64
    ds_read_b64_tr_b16 v[38:39], v10 offset:1344
    v_mfma_f32_32x32x16_bf16 v[48:63], v[24:27], v[40:43], v[48:63]
    v_mfma_f32_32x32x16_bf16 v[64:79], v[24:27], v[44:47], v[64:79]
    v_mfma_f32_32x32x16_bf16 v[80:95], v[28:31], v[40:43], v[80:95]
    v_mfma_f32_32x32x16_bf16 v[96:111], v[28:31], v[44:47], v[96:111]
    s_waitcnt vmcnt(12)
    ds_write_b128 v3, v[144:147] offset:20480
    ds_write_b128 v4, v[148:151] offset:20480
    ds_write_b128 v7, v[152:155] offset:30720
    ds_write_b128 v8, v[156:159] offset:30720
    buffer_load_dwordx4 v[144:147], v1, s[4:7], 0 offen offset:896
    buffer_load_dwordx4 v[148:151], v2, s[4:7], 0 offen offset:896
    s_mov_b32 s28, 0x17a000
    buffer_load_dwordx4 v[152:155], v5, s[8:11], s28 offen
    buffer_load_dwordx4 v[156:159], v6, s[8:11], s28 offen
    ds_read_b128 v[24:27], v9 offset:32
    ds_read_b128 v[28:31], v9 offset:2592
    ds_read_b64_tr_b16 v[40:41], v10 offset:5120
    ds_read_b64_tr_b16 v[42:43], v10 offset:6400
    ds_read_b64_tr_b16 v[44:45], v10 offset:5184
    ds_read_b64_tr_b16 v[46:47], v10 offset:6464
    s_waitcnt lgkmcnt(10)
    v_mfma_f32_32x32x16_bf16 v[48:63], v[16:19], v[32:35], v[48:63]
    v_mfma_f32_32x32x16_bf16 v[64:79], v[16:19], v[36:39], v[64:79]
    v_mfma_f32_32x32x16_bf16 v[80:95], v[20:23], v[32:35], v[80:95]
    v_mfma_f32_32x32x16_bf16 v[96:111], v[20:23], v[36:39], v[96:111]
    s_waitcnt lgkmcnt(0)
    s_barrier
    ds_read_b128 v[16:19], v9 offset:20480
    ds_read_b128 v[20:23], v9 offset:23040
    ds_read_b64_tr_b16 v[32:33], v10 offset:20480
    ds_read_b64_tr_b16 v[34:35], v10 offset:21760
    ds_read_b64_tr_b16 v[36:37], v10 offset:20544
    ds_read_b64_tr_b16 v[38:39], v10 offset:21824
    v_mfma_f32_32x32x16_bf16 v[48:63], v[24:27], v[40:43], v[48:63]
    v_mfma_f32_32x32x16_bf16 v[64:79], v[24:27], v[44:47], v[64:79]
    v_mfma_f32_32x32x16_bf16 v[80:95], v[28:31], v[40:43], v[80:95]
    v_mfma_f32_32x32x16_bf16 v[96:111], v[28:31], v[44:47], v[96:111]
    s_waitcnt vmcnt(12)
    ds_write_b128 v3, v[160:163] offset:40960
    ds_write_b128 v4, v[164:167] offset:40960
    ds_write_b128 v7, v[168:171] offset:51200
    ds_write_b128 v8, v[172:175] offset:51200
    buffer_load_dwordx4 v[160:163], v1, s[4:7], 0 offen offset:960
    buffer_load_dwordx4 v[164:167], v2, s[4:7], 0 offen offset:960
    s_mov_b32 s28, 0x195000
    buffer_load_dwordx4 v[168:171], v5, s[8:11], s28 offen
    buffer_load_dwordx4 v[172:175], v6, s[8:11], s28 offen
    ds_read_b128 v[24:27], v9 offset:20512
    ds_read_b128 v[28:31], v9 offset:23072
    ds_read_b64_tr_b16 v[40:41], v10 offset:25600
    ds_read_b64_tr_b16 v[42:43], v10 offset:26880
    ds_read_b64_tr_b16 v[44:45], v10 offset:25664
    ds_read_b64_tr_b16 v[46:47], v10 offset:26944
    s_waitcnt lgkmcnt(10)
    v_mfma_f32_32x32x16_bf16 v[48:63], v[16:19], v[32:35], v[48:63]
    v_mfma_f32_32x32x16_bf16 v[64:79], v[16:19], v[36:39], v[64:79]
    v_mfma_f32_32x32x16_bf16 v[80:95], v[20:23], v[32:35], v[80:95]
    v_mfma_f32_32x32x16_bf16 v[96:111], v[20:23], v[36:39], v[96:111]
    s_waitcnt lgkmcnt(0)
    s_barrier
    ds_read_b128 v[16:19], v9 offset:40960
    ds_read_b128 v[20:23], v9 offset:43520
    ds_read_b64_tr_b16 v[32:33], v10 offset:40960
    ds_read_b64_tr_b16 v[34:35], v10 offset:42240
    ds_read_b64_tr_b16 v[36:37], v10 offset:41024
    ds_read_b64_tr_b16 v[38:39], v10 offset:42304
    v_mfma_f32_32x32x16_bf16 v[48:63], v[24:27], v[40:43], v[48:63]
    v_mfma_f32_32x32x16_bf16 v[64:79], v[24:27], v[44:47], v[64:79]
    v_mfma_f32_32x32x16_bf16 v[80:95], v[28:31], v[40:43], v[80:95]
    v_mfma_f32_32x32x16_bf16 v[96:111], v[28:31], v[44:47], v[96:111]
    s_waitcnt vmcnt(12)
    ds_write_b128 v3, v[112:115] offset:0
    ds_write_b128 v4, v[116:119] offset:0
    ds_write_b128 v7, v[120:123] offset:10240
    ds_write_b128 v8, v[124:127] offset:10240
    buffer_load_dwordx4 v[112:115], v1, s[4:7], 0 offen offset:1024
    buffer_load_dwordx4 v[116:119], v2, s[4:7], 0 offen offset:1024
    s_mov_b32 s28, 0x1b0000
    buffer_load_dwordx4 v[120:123], v5, s[8:11], s28 offen
    buffer_load_dwordx4 v[124:127], v6, s[8:11], s28 offen
    ds_read_b128 v[24:27], v9 offset:40992
    ds_read_b128 v[28:31], v9 offset:43552
    ds_read_b64_tr_b16 v[40:41], v10 offset:46080
    ds_read_b64_tr_b16 v[42:43], v10 offset:47360
    ds_read_b64_tr_b16 v[44:45], v10 offset:46144
    ds_read_b64_tr_b16 v[46:47], v10 offset:47424
    s_waitcnt lgkmcnt(10)
    v_mfma_f32_32x32x16_bf16 v[48:63], v[16:19], v[32:35], v[48:63]
    v_mfma_f32_32x32x16_bf16 v[64:79], v[16:19], v[36:39], v[64:79]
    v_mfma_f32_32x32x16_bf16 v[80:95], v[20:23], v[32:35], v[80:95]
    v_mfma_f32_32x32x16_bf16 v[96:111], v[20:23], v[36:39], v[96:111]
    s_waitcnt lgkmcnt(0)
    s_barrier
    ds_read_b128 v[16:19], v9 offset:0
    ds_read_b128 v[20:23], v9 offset:2560
    ds_read_b64_tr_b16 v[32:33], v10 offset:0
    ds_read_b64_tr_b16 v[34:35], v10 offset:1280
    ds_read_b64_tr_b16 v[36:37], v10 offset:64
    ds_read_b64_tr_b16 v[38:39], v10 offset:1344
    v_mfma_f32_32x32x16_bf16 v[48:63], v[24:27], v[40:43], v[48:63]
    v_mfma_f32_32x32x16_bf16 v[64:79], v[24:27], v[44:47], v[64:79]
    v_mfma_f32_32x32x16_bf16 v[80:95], v[28:31], v[40:43], v[80:95]
    v_mfma_f32_32x32x16_bf16 v[96:111], v[28:31], v[44:47], v[96:111]
    s_waitcnt vmcnt(12)
    ds_write_b128 v3, v[128:131] offset:20480
    ds_write_b128 v4, v[132:135] offset:20480
    ds_write_b128 v7, v[136:139] offset:30720
    ds_write_b128 v8, v[140:143] offset:30720
    buffer_load_dwordx4 v[128:131], v1, s[4:7], 0 offen offset:1088
    buffer_load_dwordx4 v[132:135], v2, s[4:7], 0 offen offset:1088
    s_mov_b32 s28, 0x1cb000
    buffer_load_dwordx4 v[136:139], v5, s[8:11], s28 offen
    buffer_load_dwordx4 v[140:143], v6, s[8:11], s28 offen
    ds_read_b128 v[24:27], v9 offset:32
    ds_read_b128 v[28:31], v9 offset:2592
    ds_read_b64_tr_b16 v[40:41], v10 offset:5120
    ds_read_b64_tr_b16 v[42:43], v10 offset:6400
    ds_read_b64_tr_b16 v[44:45], v10 offset:5184
    ds_read_b64_tr_b16 v[46:47], v10 offset:6464
    s_waitcnt lgkmcnt(10)
    v_mfma_f32_32x32x16_bf16 v[48:63], v[16:19], v[32:35], v[48:63]
    v_mfma_f32_32x32x16_bf16 v[64:79], v[16:19], v[36:39], v[64:79]
    v_mfma_f32_32x32x16_bf16 v[80:95], v[20:23], v[32:35], v[80:95]
    v_mfma_f32_32x32x16_bf16 v[96:111], v[20:23], v[36:39], v[96:111]
    s_waitcnt lgkmcnt(0)
    s_barrier
    ds_read_b128 v[16:19], v9 offset:20480
    ds_read_b128 v[20:23], v9 offset:23040
    ds_read_b64_tr_b16 v[32:33], v10 offset:20480
    ds_read_b64_tr_b16 v[34:35], v10 offset:21760
    ds_read_b64_tr_b16 v[36:37], v10 offset:20544
    ds_read_b64_tr_b16 v[38:39], v10 offset:21824
    v_mfma_f32_32x32x16_bf16 v[48:63], v[24:27], v[40:43], v[48:63]
    v_mfma_f32_32x32x16_bf16 v[64:79], v[24:27], v[44:47], v[64:79]
    v_mfma_f32_32x32x16_bf16 v[80:95], v[28:31], v[40:43], v[80:95]
    v_mfma_f32_32x32x16_bf16 v[96:111], v[28:31], v[44:47], v[96:111]
    s_waitcnt vmcnt(12)
    ds_write_b128 v3, v[144:147] offset:40960
    ds_write_b128 v4, v[148:151] offset:40960
    ds_write_b128 v7, v[152:155] offset:51200
    ds_write_b128 v8, v[156:159] offset:51200
    ds_read_b128 v[24:27], v9 offset:20512
    ds_read_b128 v[28:31], v9 offset:23072
    ds_read_b64_tr_b16 v[40:41], v10 offset:25600
    ds_read_b64_tr_b16 v[42:43], v10 offset:26880
    ds_read_b64_tr_b16 v[44:45], v10 offset:25664
    ds_read_b64_tr_b16 v[46:47], v10 offset:26944
    s_waitcnt lgkmcnt(10)
    v_mfma_f32_32x32x16_bf16 v[48:63], v[16:19], v[32:35], v[48:63]
    v_mfma_f32_32x32x16_bf16 v[64:79], v[16:19], v[36:39], v[64:79]
    v_mfma_f32_32x32x16_bf16 v[80:95], v[20:23], v[32:35], v[80:95]
    v_mfma_f32_32x32x16_bf16 v[96:111], v[20:23], v[36:39], v[96:111]
    s_waitcnt lgkmcnt(0)
    s_barrier
    ds_read_b128 v[16:19], v9 offset:40960
    ds_read_b128 v[20:23], v9 offset:43520
    ds_read_b64_tr_b16 v[32:33], v10 offset:40960
    ds_read_b64_tr_b16 v[34:35], v10 offset:42240
    ds_read_b64_tr_b16 v[36:37], v10 offset:41024
    ds_read_b64_tr_b16 v[38:39], v10 offset:42304
    v_mfma_f32_32x32x16_bf16 v[48:63], v[24:27], v[40:43], v[48:63]
    v_mfma_f32_32x32x16_bf16 v[64:79], v[24:27], v[44:47], v[64:79]
    v_mfma_f32_32x32x16_bf16 v[80:95], v[28:31], v[40:43], v[80:95]
    v_mfma_f32_32x32x16_bf16 v[96:111], v[28:31], v[44:47], v[96:111]
    s_waitcnt vmcnt(8)
    ds_write_b128 v3, v[160:163] offset:0
    ds_write_b128 v4, v[164:167] offset:0
    ds_write_b128 v7, v[168:171] offset:10240
    ds_write_b128 v8, v[172:175] offset:10240
    ds_read_b128 v[24:27], v9 offset:40992
    ds_read_b128 v[28:31], v9 offset:43552
    ds_read_b64_tr_b16 v[40:41], v10 offset:46080
    ds_read_b64_tr_b16 v[42:43], v10 offset:47360
    ds_read_b64_tr_b16 v[44:45], v10 offset:46144
    ds_read_b64_tr_b16 v[46:47], v10 offset:47424
    s_waitcnt lgkmcnt(10)
    v_mfma_f32_32x32x16_bf16 v[48:63], v[16:19], v[32:35], v[48:63]
    v_mfma_f32_32x32x16_bf16 v[64:79], v[16:19], v[36:39], v[64:79]
    v_mfma_f32_32x32x16_bf16 v[80:95], v[20:23], v[32:35], v[80:95]
    v_mfma_f32_32x32x16_bf16 v[96:111], v[20:23], v[36:39], v[96:111]
    s_waitcnt lgkmcnt(0)
    s_barrier
    ds_read_b128 v[16:19], v9 offset:0
    ds_read_b128 v[20:23], v9 offset:2560
    ds_read_b64_tr_b16 v[32:33], v10 offset:0
    ds_read_b64_tr_b16 v[34:35], v10 offset:1280
    ds_read_b64_tr_b16 v[36:37], v10 offset:64
    ds_read_b64_tr_b16 v[38:39], v10 offset:1344
    v_mfma_f32_32x32x16_bf16 v[48:63], v[24:27], v[40:43], v[48:63]
    v_mfma_f32_32x32x16_bf16 v[64:79], v[24:27], v[44:47], v[64:79]
    v_mfma_f32_32x32x16_bf16 v[80:95], v[28:31], v[40:43], v[80:95]
    v_mfma_f32_32x32x16_bf16 v[96:111], v[28:31], v[44:47], v[96:111]
    s_waitcnt vmcnt(4)
    ds_write_b128 v3, v[112:115] offset:20480
    ds_write_b128 v4, v[116:119] offset:20480
    ds_write_b128 v7, v[120:123] offset:30720
    ds_write_b128 v8, v[124:127] offset:30720
    ds_read_b128 v[24:27], v9 offset:32
    ds_read_b128 v[28:31], v9 offset:2592
    ds_read_b64_tr_b16 v[40:41], v10 offset:5120
    ds_read_b64_tr_b16 v[42:43], v10 offset:6400
    ds_read_b64_tr_b16 v[44:45], v10 offset:5184
    ds_read_b64_tr_b16 v[46:47], v10 offset:6464
    s_waitcnt lgkmcnt(10)
    v_mfma_f32_32x32x16_bf16 v[48:63], v[16:19], v[32:35], v[48:63]
    v_mfma_f32_32x32x16_bf16 v[64:79], v[16:19], v[36:39], v[64:79]
    v_mfma_f32_32x32x16_bf16 v[80:95], v[20:23], v[32:35], v[80:95]
    v_mfma_f32_32x32x16_bf16 v[96:111], v[20:23], v[36:39], v[96:111]
    s_waitcnt lgkmcnt(0)
    s_barrier
    ds_read_b128 v[16:19], v9 offset:20480
    ds_read_b128 v[20:23], v9 offset:23040
    ds_read_b64_tr_b16 v[32:33], v10 offset:20480
    ds_read_b64_tr_b16 v[34:35], v10 offset:21760
    ds_read_b64_tr_b16 v[36:37], v10 offset:20544
    ds_read_b64_tr_b16 v[38:39], v10 offset:21824
    v_mfma_f32_32x32x16_bf16 v[48:63], v[24:27], v[40:43], v[48:63]
    v_mfma_f32_32x32x16_bf16 v[64:79], v[24:27], v[44:47], v[64:79]
    v_mfma_f32_32x32x16_bf16 v[80:95], v[28:31], v[40:43], v[80:95]
    v_mfma_f32_32x32x16_bf16 v[96:111], v[28:31], v[44:47], v[96:111]
    s_waitcnt vmcnt(0)
    ds_write_b128 v3, v[128:131] offset:40960
    ds_write_b128 v4, v[132:135] offset:40960
    ds_write_b128 v7, v[136:139] offset:51200
    ds_write_b128 v8, v[140:143] offset:51200
    ds_read_b128 v[24:27], v9 offset:20512
    ds_read_b128 v[28:31], v9 offset:23072
    ds_read_b64_tr_b16 v[40:41], v10 offset:25600
    ds_read_b64_tr_b16 v[42:43], v10 offset:26880
    ds_read_b64_tr_b16 v[44:45], v10 offset:25664
    ds_read_b64_tr_b16 v[46:47], v10 offset:26944
    s_waitcnt lgkmcnt(10)
    v_mfma_f32_32x32x16_bf16 v[48:63], v[16:19], v[32:35], v[48:63]
    v_mfma_f32_32x32x16_bf16 v[64:79], v[16:19], v[36:39], v[64:79]
    v_mfma_f32_32x32x16_bf16 v[80:95], v[20:23], v[32:35], v[80:95]
    v_mfma_f32_32x32x16_bf16 v[96:111], v[20:23], v[36:39], v[96:111]
    s_waitcnt lgkmcnt(0)
    s_barrier
    ds_read_b128 v[16:19], v9 offset:40960
    ds_read_b128 v[20:23], v9 offset:43520
    ds_read_b64_tr_b16 v[32:33], v10 offset:40960
    ds_read_b64_tr_b16 v[34:35], v10 offset:42240
    ds_read_b64_tr_b16 v[36:37], v10 offset:41024
    ds_read_b64_tr_b16 v[38:39], v10 offset:42304
    v_mfma_f32_32x32x16_bf16 v[48:63], v[24:27], v[40:43], v[48:63]
    v_mfma_f32_32x32x16_bf16 v[64:79], v[24:27], v[44:47], v[64:79]
    v_mfma_f32_32x32x16_bf16 v[80:95], v[28:31], v[40:43], v[80:95]
    v_mfma_f32_32x32x16_bf16 v[96:111], v[28:31], v[44:47], v[96:111]
    ds_read_b128 v[24:27], v9 offset:40992
    ds_read_b128 v[28:31], v9 offset:43552
    ds_read_b64_tr_b16 v[40:41], v10 offset:46080
    ds_read_b64_tr_b16 v[42:43], v10 offset:47360
    ds_read_b64_tr_b16 v[44:45], v10 offset:46144
    ds_read_b64_tr_b16 v[46:47], v10 offset:47424
    s_waitcnt lgkmcnt(6)
    v_mfma_f32_32x32x16_bf16 v[48:63], v[16:19], v[32:35], v[48:63]
    v_mfma_f32_32x32x16_bf16 v[64:79], v[16:19], v[36:39], v[64:79]
    v_mfma_f32_32x32x16_bf16 v[80:95], v[20:23], v[32:35], v[80:95]
    v_mfma_f32_32x32x16_bf16 v[96:111], v[20:23], v[36:39], v[96:111]
    s_waitcnt lgkmcnt(0)
    v_mfma_f32_32x32x16_bf16 v[48:63], v[24:27], v[40:43], v[48:63]
    v_mfma_f32_32x32x16_bf16 v[64:79], v[24:27], v[44:47], v[64:79]
    v_mfma_f32_32x32x16_bf16 v[80:95], v[28:31], v[40:43], v[80:95]
    v_mfma_f32_32x32x16_bf16 v[96:111], v[28:31], v[44:47], v[96:111]
    v_lshrrev_b32 v11, 6, v0
    v_lshrrev_b32 v12, 1, v11
    v_and_b32 v11, 1, v11
    v_mul_u32_u24 v11, 64, v11
    v_and_b32 v13, 31, v0
    v_add3_u32 v11, v11, v13, s27
    s_nop 0
    v_readfirstlane_b32 s28, v11
    s_cmp_lt_u32 s28, 576
    s_cselect_b32 s28, 0x3eae1a93, 1.0
    v_lshlrev_b32 v11, 12, v11
    v_mul_u32_u24 v12, 64, v12
    v_bfe_u32 v13, v0, 5, 1
    v_lshl_add_u32 v12, v13, 2, v12
    v_add_u32 v12, s26, v12
    v_lshl_add_u32 v11, v12, 1, v11
    v_mul_f32 v48, s28, v48
    v_mul_f32 v49, s28, v49
    v_mul_f32 v50, s28, v50
    v_mul_f32 v51, s28, v51
    v_mul_f32 v52, s28, v52
    v_mul_f32 v53, s28, v53
    v_mul_f32 v54, s28, v54
    v_mul_f32 v55, s28, v55
    v_mul_f32 v56, s28, v56
    v_mul_f32 v57, s28, v57
    v_mul_f32 v58, s28, v58
    v_mul_f32 v59, s28, v59
    v_mul_f32 v60, s28, v60
    v_mul_f32 v61, s28, v61
    v_mul_f32 v62, s28, v62
    v_mul_f32 v63, s28, v63
    v_cvt_pk_bf16_f32 v48, v48, v49
    v_cvt_pk_bf16_f32 v49, v50, v51
    v_cvt_pk_bf16_f32 v50, v52, v53
    v_cvt_pk_bf16_f32 v51, v54, v55
    v_cvt_pk_bf16_f32 v52, v56, v57
    v_cvt_pk_bf16_f32 v53, v58, v59
    v_cvt_pk_bf16_f32 v54, v60, v61
    v_cvt_pk_bf16_f32 v55, v62, v63
    s_mov_b32 s29, 0x0
    buffer_store_dwordx2 v[48:49], v11, s[12:15], s29 offen offset:0
    buffer_store_dwordx2 v[50:51], v11, s[12:15], s29 offen offset:16
    buffer_store_dwordx2 v[52:53], v11, s[12:15], s29 offen offset:32
    buffer_store_dwordx2 v[54:55], v11, s[12:15], s29 offen offset:48
    v_mul_f32 v64, s28, v64
    v_mul_f32 v65, s28, v65
    v_mul_f32 v66, s28, v66
    v_mul_f32 v67, s28, v67
    v_mul_f32 v68, s28, v68
    v_mul_f32 v69, s28, v69
    v_mul_f32 v70, s28, v70
    v_mul_f32 v71, s28, v71
    v_mul_f32 v72, s28, v72
    v_mul_f32 v73, s28, v73
    v_mul_f32 v74, s28, v74
    v_mul_f32 v75, s28, v75
    v_mul_f32 v76, s28, v76
    v_mul_f32 v77, s28, v77
    v_mul_f32 v78, s28, v78
    v_mul_f32 v79, s28, v79
    v_cvt_pk_bf16_f32 v64, v64, v65
    v_cvt_pk_bf16_f32 v65, v66, v67
    v_cvt_pk_bf16_f32 v66, v68, v69
    v_cvt_pk_bf16_f32 v67, v70, v71
    v_cvt_pk_bf16_f32 v68, v72, v73
    v_cvt_pk_bf16_f32 v69, v74, v75
    v_cvt_pk_bf16_f32 v70, v76, v77
    v_cvt_pk_bf16_f32 v71, v78, v79
    s_mov_b32 s29, 0x20000
    buffer_store_dwordx2 v[64:65], v11, s[12:15], s29 offen offset:0
    buffer_store_dwordx2 v[66:67], v11, s[12:15], s29 offen offset:16
    buffer_store_dwordx2 v[68:69], v11, s[12:15], s29 offen offset:32
    buffer_store_dwordx2 v[70:71], v11, s[12:15], s29 offen offset:48
    v_mul_f32 v80, s28, v80
    v_mul_f32 v81, s28, v81
    v_mul_f32 v82, s28, v82
    v_mul_f32 v83, s28, v83
    v_mul_f32 v84, s28, v84
    v_mul_f32 v85, s28, v85
    v_mul_f32 v86, s28, v86
    v_mul_f32 v87, s28, v87
    v_mul_f32 v88, s28, v88
    v_mul_f32 v89, s28, v89
    v_mul_f32 v90, s28, v90
    v_mul_f32 v91, s28, v91
    v_mul_f32 v92, s28, v92
    v_mul_f32 v93, s28, v93
    v_mul_f32 v94, s28, v94
    v_mul_f32 v95, s28, v95
    v_cvt_pk_bf16_f32 v80, v80, v81
    v_cvt_pk_bf16_f32 v81, v82, v83
    v_cvt_pk_bf16_f32 v82, v84, v85
    v_cvt_pk_bf16_f32 v83, v86, v87
    v_cvt_pk_bf16_f32 v84, v88, v89
    v_cvt_pk_bf16_f32 v85, v90, v91
    v_cvt_pk_bf16_f32 v86, v92, v93
    v_cvt_pk_bf16_f32 v87, v94, v95
    s_mov_b32 s29, 0x0
    buffer_store_dwordx2 v[80:81], v11, s[12:15], s29 offen offset:64
    buffer_store_dwordx2 v[82:83], v11, s[12:15], s29 offen offset:80
    buffer_store_dwordx2 v[84:85], v11, s[12:15], s29 offen offset:96
    buffer_store_dwordx2 v[86:87], v11, s[12:15], s29 offen offset:112
    v_mul_f32 v96, s28, v96
    v_mul_f32 v97, s28, v97
    v_mul_f32 v98, s28, v98
    v_mul_f32 v99, s28, v99
    v_mul_f32 v100, s28, v100
    v_mul_f32 v101, s28, v101
    v_mul_f32 v102, s28, v102
    v_mul_f32 v103, s28, v103
    v_mul_f32 v104, s28, v104
    v_mul_f32 v105, s28, v105
    v_mul_f32 v106, s28, v106
    v_mul_f32 v107, s28, v107
    v_mul_f32 v108, s28, v108
    v_mul_f32 v109, s28, v109
    v_mul_f32 v110, s28, v110
    v_mul_f32 v111, s28, v111
    v_cvt_pk_bf16_f32 v96, v96, v97
    v_cvt_pk_bf16_f32 v97, v98, v99
    v_cvt_pk_bf16_f32 v98, v100, v101
    v_cvt_pk_bf16_f32 v99, v102, v103
    v_cvt_pk_bf16_f32 v100, v104, v105
    v_cvt_pk_bf16_f32 v101, v106, v107
    v_cvt_pk_bf16_f32 v102, v108, v109
    v_cvt_pk_bf16_f32 v103, v110, v111
    s_mov_b32 s29, 0x20000
    buffer_store_dwordx2 v[96:97], v11, s[12:15], s29 offen offset:64
    buffer_store_dwordx2 v[98:99], v11, s[12:15], s29 offen offset:80
    buffer_store_dwordx2 v[100:101], v11, s[12:15], s29 offen offset:96
    buffer_store_dwordx2 v[102:103], v11, s[12:15], s29 offen offset:112
    s_endpgm
VPART_4:
    s_sub_u32 s27, s2, 144
    s_and_b32 s26, s27, 15
    s_lshl_b32 s26, s26, 7
    s_lshr_b32 s27, s27, 4
    s_mul_i32 s27, s27, 96
    s_add_u32 s27, s27, 1152
    v_lshrrev_b32 v11, 2, v0
    v_and_b32 v12, 3, v0
    v_lshlrev_b32 v12, 4, v12
    v_mul_u32_u24 v3, 80, v11
    v_add_u32 v3, v3, v12
    v_add_u32 v11, s26, v11
    v_mul_u32_u24 v1, 1152, v11
    v_add_u32 v1, v1, v12
    v_lshrrev_b32 v11, 2, v0
    v_add_u32 v11, 64, v11
    v_and_b32 v12, 3, v0
    v_lshlrev_b32 v12, 4, v12
    v_mul_u32_u24 v4, 80, v11
    v_add_u32 v4, v4, v12
    v_add_u32 v11, s26, v11
    v_mul_u32_u24 v2, 1152, v11
    v_add_u32 v2, v2, v12
    v_add_u32 v13, 0, v0
    v_mul_u32_u24 v11, 5462, v13
    v_lshrrev_b32 v11, 16, v11
    v_mul_u32_u24 v14, 12, v11
    v_sub_u32 v12, v13, v14
    v_lshlrev_b32 v12, 4, v12
    v_mul_u32_u24 v7, 192, v11
    v_add_u32 v7, v7, v12
    v_mul_u32_u24 v5, 3456, v11
    v_add_u32 v5, v5, v12
    v_add_u32 v5, s27, v5
    v_add_u32 v5, s27, v5
    v_add_u32 v13, 256, v0
    v_mul_u32_u24 v11, 5462, v13
    v_lshrrev_b32 v11, 16, v11
    v_mul_u32_u24 v14, 12, v11
    v_sub_u32 v12, v13, v14
    v_lshlrev_b32 v12, 4, v12
    v_mul_u32_u24 v8, 192, v11
    v_add_u32 v8, v8, v12
    v_mul_u32_u24 v6, 3456, v11
    v_add_u32 v6, v6, v12
    v_add_u32 v6, s27, v6
    v_add_u32 v6, s27, v6
    v_cmp_gt_u32 vcc, 128, v0
    s_mov_b64 s[30:31], vcc
    v_lshrrev_b32 v11, 6, v0
    v_mov_b32 v12, v11
    v_mov_b32 v11, 0
    v_mul_u32_u24 v12, 32, v12
    v_and_b32 v13, 31, v0
    v_add_u32 v12, v12, v13
    v_mul_u32_u24 v9, 80, v12
    v_bfe_u32 v13, v0, 5, 1
    v_lshl_add_u32 v9, v13, 4, v9
    v_bfe_u32 v12, v0, 2, 2
    v_lshl_add_u32 v12, v13, 3, v12
    v_mul_u32_u24 v10, 192, v12
    v_mul_u32_u24 v11, 192, v11
    v_add_u32 v10, v10, v11
    v_bfe_u32 v11, v0, 4, 1
    v_lshl_add_u32 v10, v11, 5, v10
    v_and_b32 v11, 3, v0
    v_lshl_add_u32 v10, v11, 3, v10
    v_add_u32 v10, 10240, v10
    buffer_load_dwordx4 v[96:99], v1, s[4:7], 0 offen offset:0
    buffer_load_dwordx4 v[100:103], v2, s[4:7], 0 offen offset:0
    s_mov_b32 s28, 0x0
    buffer_load_dwordx4 v[104:107], v5, s[8:11], s28 offen
    s_mov_b64 exec, s[30:31]
    buffer_load_dwordx4 v[108:111], v6, s[8:11], s28 offen
    s_mov_b64 exec, -1
    buffer_load_dwordx4 v[112:115], v1, s[4:7], 0 offen offset:64
    buffer_load_dwordx4 v[116:119], v2, s[4:7], 0 offen offset:64
    s_mov_b32 s28, 0x1b000
    buffer_load_dwordx4 v[120:123], v5, s[8:11], s28 offen
    s_mov_b64 exec, s[30:31]
    buffer_load_dwordx4 v[124:127], v6, s[8:11], s28 offen
    s_mov_b64 exec, -1
    buffer_load_dwordx4 v[128:131], v1, s[4:7], 0 offen offset:128
    buffer_load_dwordx4 v[132:135], v2, s[4:7], 0 offen offset:128
    s_mov_b32 s28, 0x36000
    buffer_load_dwordx4 v[136:139], v5, s[8:11], s28 offen
    s_mov_b64 exec, s[30:31]
    buffer_load_dwordx4 v[140:143], v6, s[8:11], s28 offen
    s_mov_b64 exec, -1
    buffer_load_dwordx4 v[144:147], v1, s[4:7], 0 offen offset:192
    buffer_load_dwordx4 v[148:151], v2, s[4:7], 0 offen offset:192
    s_mov_b32 s28, 0x51000
    buffer_load_dwordx4 v[152:155], v5, s[8:11], s28 offen
    s_mov_b64 exec, s[30:31]
    buffer_load_dwordx4 v[156:159], v6, s[8:11], s28 offen
    s_mov_b64 exec, -1
    s_waitcnt vmcnt(12)
    ds_write_b128 v3, v[96:99] offset:0
    ds_write_b128 v4, v[100:103] offset:0
    ds_write_b128 v7, v[104:107] offset:10240
    s_mov_b64 exec, s[30:31]
    ds_write_b128 v8, v[108:111] offset:10240
    s_mov_b64 exec, -1
    buffer_load_dwordx4 v[96:99], v1, s[4:7], 0 offen offset:256
    buffer_load_dwordx4 v[100:103], v2, s[4:7], 0 offen offset:256
    s_mov_b32 s28, 0x6c000
    buffer_load_dwordx4 v[104:107], v5, s[8:11], s28 offen
    s_mov_b64 exec, s[30:31]
    buffer_load_dwordx4 v[108:111], v6, s[8:11], s28 offen
    s_mov_b64 exec, -1
    s_waitcnt lgkmcnt(0)
    s_barrier
    ds_read_b128 v[16:19], v9 offset:0
    ds_read_b64_tr_b16 v[24:25], v10 offset:0
    ds_read_b64_tr_b16 v[26:27], v10 offset:768
    ds_read_b64_tr_b16 v[28:29], v10 offset:64
    ds_read_b64_tr_b16 v[30:31], v10 offset:832
    ds_read_b64_tr_b16 v[32:33], v10 offset:128
    ds_read_b64_tr_b16 v[34:35], v10 offset:896
    s_waitcnt vmcnt(12)
    ds_write_b128 v3, v[112:115] offset:16384
    ds_write_b128 v4, v[116:119] offset:16384
    ds_write_b128 v7, v[120:123] offset:26624
    s_mov_b64 exec, s[30:31]
    ds_write_b128 v8, v[124:127] offset:26624
    s_mov_b64 exec, -1
    buffer_load_dwordx4 v[112:115], v1, s[4:7], 0 offen offset:320
    buffer_load_dwordx4 v[116:119], v2, s[4:7], 0 offen offset:320
    s_mov_b32 s28, 0x87000
    buffer_load_dwordx4 v[120:123], v5, s[8:11], s28 offen
    s_mov_b64 exec, s[30:31]
    buffer_load_dwordx4 v[124:127], v6, s[8:11], s28 offen
    s_mov_b64 exec, -1
    ds_read_b128 v[20:23], v9 offset:32
    ds_read_b64_tr_b16 v[36:37], v10 offset:3072
    ds_read_b64_tr_b16 v[38:39], v10 offset:3840
    ds_read_b64_tr_b16 v[40:41], v10 offset:3136
    ds_read_b64_tr_b16 v[42:43], v10 offset:3904
    ds_read_b64_tr_b16 v[44:45], v10 offset:3200
    ds_read_b64_tr_b16 v[46:47], v10 offset:3968
    s_waitcnt lgkmcnt(11)
    v_mfma_f32_32x32x16_bf16 v[48:63], v[16:19], v[24:27], 0
    v_mfma_f32_32x32x16_bf16 v[64:79], v[16:19], v[28:31], 0
    v_mfma_f32_32x32x16_bf16 v[80:95], v[16:19], v[32:35], 0
    s_waitcnt lgkmcnt(0)
    s_barrier
    ds_read_b128 v[16:19], v9 offset:16384
    ds_read_b64_tr_b16 v[24:25], v10 offset:16384
    ds_read_b64_tr_b16 v[26:27], v10 offset:17152
    ds_read_b64_tr_b16 v[28:29], v10 offset:16448
    ds_read_b64_tr_b16 v[30:31], v10 offset:17216
    ds_read_b64_tr_b16 v[32:33], v10 offset:16512
    ds_read_b64_tr_b16 v[34:35], v10 offset:17280
    v_mfma_f32_32x32x16_bf16 v[48:63], v[20:23], v[36:39], v[48:63]
    v_mfma_f32_32x32x16_bf16 v[64:79], v[20:23], v[40:43], v[64:79]
    v_mfma_f32_32x32x16_bf16 v[80:95], v[20:23], v[44:47], v[80:95]
    s_waitcnt vmcnt(12)
    ds_write_b128 v3, v[128:131] offset:32768
    ds_write_b128 v4, v[132:135] offset:32768
    ds_write_b128 v7, v[136:139] offset:43008
    s_mov_b64 exec, s[30:31]
    ds_write_b128 v8, v[140:143] offset:43008
    s_mov_b64 exec, -1
    buffer_load_dwordx4 v[128:131], v1, s[4:7], 0 offen offset:384
    buffer_load_dwordx4 v[132:135], v2, s[4:7], 0 offen offset:384
    s_mov_b32 s28, 0xa2000
    buffer_load_dwordx4 v[136:139], v5, s[8:11], s28 offen
    s_mov_b64 exec, s[30:31]
    buffer_load_dwordx4 v[140:143], v6, s[8:11], s28 offen
    s_mov_b64 exec, -1
    ds_read_b128 v[20:23], v9 offset:16416
    ds_read_b64_tr_b16 v[36:37], v10 offset:19456
    ds_read_b64_tr_b16 v[38:39], v10 offset:20224
    ds_read_b64_tr_b16 v[40:41], v10 offset:19520
    ds_read_b64_tr_b16 v[42:43], v10 offset:20288
    ds_read_b64_tr_b16 v[44:45], v10 offset:19584
    ds_read_b64_tr_b16 v[46:47], v10 offset:20352
    s_waitcnt lgkmcnt(11)
    v_mfma_f32_32x32x16_bf16 v[48:63], v[16:19], v[24:27], v[48:63]
    v_mfma_f32_32x32x16_bf16 v[64:79], v[16:19], v[28:31], v[64:79]
    v_mfma_f32_32x32x16_bf16 v[80:95], v[16:19], v[32:35], v[80:95]
    s_waitcnt lgkmcnt(0)
    s_barrier
    ds_read_b128 v[16:19], v9 offset:32768
    ds_read_b64_tr_b16 v[24:25], v10 offset:32768
    ds_read_b64_tr_b16 v[26:27], v10 offset:33536
    ds_read_b64_tr_b16 v[28:29], v10 offset:32832
    ds_read_b64_tr_b16 v[30:31], v10 offset:33600
    ds_read_b64_tr_b16 v[32:33], v10 offset:32896
    ds_read_b64_tr_b16 v[34:35], v10 offset:33664
    v_mfma_f32_32x32x16_bf16 v[48:63], v[20:23], v[36:39], v[48:63]
    v_mfma_f32_32x32x16_bf16 v[64:79], v[20:23], v[40:43], v[64:79]
    v_mfma_f32_32x32x16_bf16 v[80:95], v[20:23], v[44:47], v[80:95]
    s_waitcnt vmcnt(12)
    ds_write_b128 v3, v[144:147] offset:0
    ds_write_b128 v4, v[148:151] offset:0
    ds_write_b128 v7, v[152:155] offset:10240
    s_mov_b64 exec, s[30:31]
    ds_write_b128 v8, v[156:159] offset:10240
    s_mov_b64 exec, -1
    buffer_load_dwordx4 v[144:147], v1, s[4:7], 0 offen offset:448
    buffer_load_dwordx4 v[148:151], v2, s[4:7], 0 offen offset:448
    s_mov_b32 s28, 0xbd000
    buffer_load_dwordx4 v[152:155], v5, s[8:11], s28 offen
    s_mov_b64 exec, s[30:31]
    buffer_load_dwordx4 v[156:159], v6, s[8:11], s28 offen
    s_mov_b64 exec, -1
    ds_read_b128 v[20:23], v9 offset:32800
    ds_read_b64_tr_b16 v[36:37], v10 offset:35840
    ds_read_b64_tr_b16 v[38:39], v10 offset:36608
    ds_read_b64_tr_b16 v[40:41], v10 offset:35904
    ds_read_b64_tr_b16 v[42:43], v10 offset:36672
    ds_read_b64_tr_b16 v[44:45], v10 offset:35968
    ds_read_b64_tr_b16 v[46:47], v10 offset:36736
    s_waitcnt lgkmcnt(11)
    v_mfma_f32_32x32x16_bf16 v[48:63], v[16:19], v[24:27], v[48:63]
    v_mfma_f32_32x32x16_bf16 v[64:79], v[16:19], v[28:31], v[64:79]
    v_mfma_f32_32x32x16_bf16 v[80:95], v[16:19], v[32:35], v[80:95]
    s_waitcnt lgkmcnt(0)
    s_barrier
    ds_read_b128 v[16:19], v9 offset:0
    ds_read_b64_tr_b16 v[24:25], v10 offset:0
    ds_read_b64_tr_b16 v[26:27], v10 offset:768
    ds_read_b64_tr_b16 v[28:29], v10 offset:64
    ds_read_b64_tr_b16 v[30:31], v10 offset:832
    ds_read_b64_tr_b16 v[32:33], v10 offset:128
    ds_read_b64_tr_b16 v[34:35], v10 offset:896
    v_mfma_f32_32x32x16_bf16 v[48:63], v[20:23], v[36:39], v[48:63]
    v_mfma_f32_32x32x16_bf16 v[64:79], v[20:23], v[40:43], v[64:79]
    v_mfma_f32_32x32x16_bf16 v[80:95], v[20:23], v[44:47], v[80:95]
    s_waitcnt vmcnt(12)
    ds_write_b128 v3, v[96:99] offset:16384
    ds_write_b128 v4, v[100:103] offset:16384
    ds_write_b128 v7, v[104:107] offset:26624
    s_mov_b64 exec, s[30:31]
    ds_write_b128 v8, v[108:111] offset:26624
    s_mov_b64 exec, -1
    buffer_load_dwordx4 v[96:99], v1, s[4:7], 0 offen offset:512
    buffer_load_dwordx4 v[100:103], v2, s[4:7], 0 offen offset:512
    s_mov_b32 s28, 0xd8000
    buffer_load_dwordx4 v[104:107], v5, s[8:11], s28 offen
    s_mov_b64 exec, s[30:31]
    buffer_load_dwordx4 v[108:111], v6, s[8:11], s28 offen
    s_mov_b64 exec, -1
    ds_read_b128 v[20:23], v9 offset:32
    ds_read_b64_tr_b16 v[36:37], v10 offset:3072
    ds_read_b64_tr_b16 v[38:39], v10 offset:3840
    ds_read_b64_tr_b16 v[40:41], v10 offset:3136
    ds_read_b64_tr_b16 v[42:43], v10 offset:3904
    ds_read_b64_tr_b16 v[44:45], v10 offset:3200
    ds_read_b64_tr_b16 v[46:47], v10 offset:3968
    s_waitcnt lgkmcnt(11)
    v_mfma_f32_32x32x16_bf16 v[48:63], v[16:19], v[24:27], v[48:63]
    v_mfma_f32_32x32x16_bf16 v[64:79], v[16:19], v[28:31], v[64:79]
    v_mfma_f32_32x32x16_bf16 v[80:95], v[16:19], v[32:35], v[80:95]
    s_waitcnt lgkmcnt(0)
    s_barrier
    ds_read_b128 v[16:19], v9 offset:16384
    ds_read_b64_tr_b16 v[24:25], v10 offset:16384
    ds_read_b64_tr_b16 v[26:27], v10 offset:17152
    ds_read_b64_tr_b16 v[28:29], v10 offset:16448
    ds_read_b64_tr_b16 v[30:31], v10 offset:17216
    ds_read_b64_tr_b16 v[32:33], v10 offset:16512
    ds_read_b64_tr_b16 v[34:35], v10 offset:17280
    v_mfma_f32_32x32x16_bf16 v[48:63], v[20:23], v[36:39], v[48:63]
    v_mfma_f32_32x32x16_bf16 v[64:79], v[20:23], v[40:43], v[64:79]
    v_mfma_f32_32x32x16_bf16 v[80:95], v[20:23], v[44:47], v[80:95]
    s_waitcnt vmcnt(12)
    ds_write_b128 v3, v[112:115] offset:32768
    ds_write_b128 v4, v[116:119] offset:32768
    ds_write_b128 v7, v[120:123] offset:43008
    s_mov_b64 exec, s[30:31]
    ds_write_b128 v8, v[124:127] offset:43008
    s_mov_b64 exec, -1
    buffer_load_dwordx4 v[112:115], v1, s[4:7], 0 offen offset:576
    buffer_load_dwordx4 v[116:119], v2, s[4:7], 0 offen offset:576
    s_mov_b32 s28, 0xf3000
    buffer_load_dwordx4 v[120:123], v5, s[8:11], s28 offen
    s_mov_b64 exec, s[30:31]
    buffer_load_dwordx4 v[124:127], v6, s[8:11], s28 offen
    s_mov_b64 exec, -1
    ds_read_b128 v[20:23], v9 offset:16416
    ds_read_b64_tr_b16 v[36:37], v10 offset:19456
    ds_read_b64_tr_b16 v[38:39], v10 offset:20224
    ds_read_b64_tr_b16 v[40:41], v10 offset:19520
    ds_read_b64_tr_b16 v[42:43], v10 offset:20288
    ds_read_b64_tr_b16 v[44:45], v10 offset:19584
    ds_read_b64_tr_b16 v[46:47], v10 offset:20352
    s_waitcnt lgkmcnt(11)
    v_mfma_f32_32x32x16_bf16 v[48:63], v[16:19], v[24:27], v[48:63]
    v_mfma_f32_32x32x16_bf16 v[64:79], v[16:19], v[28:31], v[64:79]
    v_mfma_f32_32x32x16_bf16 v[80:95], v[16:19], v[32:35], v[80:95]
    s_waitcnt lgkmcnt(0)
    s_barrier
    ds_read_b128 v[16:19], v9 offset:32768
    ds_read_b64_tr_b16 v[24:25], v10 offset:32768
    ds_read_b64_tr_b16 v[26:27], v10 offset:33536
    ds_read_b64_tr_b16 v[28:29], v10 offset:32832
    ds_read_b64_tr_b16 v[30:31], v10 offset:33600
    ds_read_b64_tr_b16 v[32:33], v10 offset:32896
    ds_read_b64_tr_b16 v[34:35], v10 offset:33664
    v_mfma_f32_32x32x16_bf16 v[48:63], v[20:23], v[36:39], v[48:63]
    v_mfma_f32_32x32x16_bf16 v[64:79], v[20:23], v[40:43], v[64:79]
    v_mfma_f32_32x32x16_bf16 v[80:95], v[20:23], v[44:47], v[80:95]
    s_waitcnt vmcnt(12)
    ds_write_b128 v3, v[128:131] offset:0
    ds_write_b128 v4, v[132:135] offset:0
    ds_write_b128 v7, v[136:139] offset:10240
    s_mov_b64 exec, s[30:31]
    ds_write_b128 v8, v[140:143] offset:10240
    s_mov_b64 exec, -1
    buffer_load_dwordx4 v[128:131], v1, s[4:7], 0 offen offset:640
    buffer_load_dwordx4 v[132:135], v2, s[4:7], 0 offen offset:640
    s_mov_b32 s28, 0x10e000
    buffer_load_dwordx4 v[136:139], v5, s[8:11], s28 offen
    s_mov_b64 exec, s[30:31]
    buffer_load_dwordx4 v[140:143], v6, s[8:11], s28 offen
    s_mov_b64 exec, -1
    ds_read_b128 v[20:23], v9 offset:32800
    ds_read_b64_tr_b16 v[36:37], v10 offset:35840
    ds_read_b64_tr_b16 v[38:39], v10 offset:36608
    ds_read_b64_tr_b16 v[40:41], v10 offset:35904
    ds_read_b64_tr_b16 v[42:43], v10 offset:36672
    ds_read_b64_tr_b16 v[44:45], v10 offset:35968
    ds_read_b64_tr_b16 v[46:47], v10 offset:36736
    s_waitcnt lgkmcnt(11)
    v_mfma_f32_32x32x16_bf16 v[48:63], v[16:19], v[24:27], v[48:63]
    v_mfma_f32_32x32x16_bf16 v[64:79], v[16:19], v[28:31], v[64:79]
    v_mfma_f32_32x32x16_bf16 v[80:95], v[16:19], v[32:35], v[80:95]
    s_waitcnt lgkmcnt(0)
    s_barrier
    ds_read_b128 v[16:19], v9 offset:0
    ds_read_b64_tr_b16 v[24:25], v10 offset:0
    ds_read_b64_tr_b16 v[26:27], v10 offset:768
    ds_read_b64_tr_b16 v[28:29], v10 offset:64
    ds_read_b64_tr_b16 v[30:31], v10 offset:832
    ds_read_b64_tr_b16 v[32:33], v10 offset:128
    ds_read_b64_tr_b16 v[34:35], v10 offset:896
    v_mfma_f32_32x32x16_bf16 v[48:63], v[20:23], v[36:39], v[48:63]
    v_mfma_f32_32x32x16_bf16 v[64:79], v[20:23], v[40:43], v[64:79]
    v_mfma_f32_32x32x16_bf16 v[80:95], v[20:23], v[44:47], v[80:95]
    s_waitcnt vmcnt(12)
    ds_write_b128 v3, v[144:147] offset:16384
    ds_write_b128 v4, v[148:151] offset:16384
    ds_write_b128 v7, v[152:155] offset:26624
    s_mov_b64 exec, s[30:31]
    ds_write_b128 v8, v[156:159] offset:26624
    s_mov_b64 exec, -1
    buffer_load_dwordx4 v[144:147], v1, s[4:7], 0 offen offset:704
    buffer_load_dwordx4 v[148:151], v2, s[4:7], 0 offen offset:704
    s_mov_b32 s28, 0x129000
    buffer_load_dwordx4 v[152:155], v5, s[8:11], s28 offen
    s_mov_b64 exec, s[30:31]
    buffer_load_dwordx4 v[156:159], v6, s[8:11], s28 offen
    s_mov_b64 exec, -1
    ds_read_b128 v[20:23], v9 offset:32
    ds_read_b64_tr_b16 v[36:37], v10 offset:3072
    ds_read_b64_tr_b16 v[38:39], v10 offset:3840
    ds_read_b64_tr_b16 v[40:41], v10 offset:3136
    ds_read_b64_tr_b16 v[42:43], v10 offset:3904
    ds_read_b64_tr_b16 v[44:45], v10 offset:3200
    ds_read_b64_tr_b16 v[46:47], v10 offset:3968
    s_waitcnt lgkmcnt(11)
    v_mfma_f32_32x32x16_bf16 v[48:63], v[16:19], v[24:27], v[48:63]
    v_mfma_f32_32x32x16_bf16 v[64:79], v[16:19], v[28:31], v[64:79]
    v_mfma_f32_32x32x16_bf16 v[80:95], v[16:19], v[32:35], v[80:95]
    s_waitcnt lgkmcnt(0)
    s_barrier
    ds_read_b128 v[16:19], v9 offset:16384
    ds_read_b64_tr_b16 v[24:25], v10 offset:16384
    ds_read_b64_tr_b16 v[26:27], v10 offset:17152
    ds_read_b64_tr_b16 v[28:29], v10 offset:16448
    ds_read_b64_tr_b16 v[30:31], v10 offset:17216
    ds_read_b64_tr_b16 v[32:33], v10 offset:16512
    ds_read_b64_tr_b16 v[34:35], v10 offset:17280
    v_mfma_f32_32x32x16_bf16 v[48:63], v[20:23], v[36:39], v[48:63]
    v_mfma_f32_32x32x16_bf16 v[64:79], v[20:23], v[40:43], v[64:79]
    v_mfma_f32_32x32x16_bf16 v[80:95], v[20:23], v[44:47], v[80:95]
    s_waitcnt vmcnt(12)
    ds_write_b128 v3, v[96:99] offset:32768
    ds_write_b128 v4, v[100:103] offset:32768
    ds_write_b128 v7, v[104:107] offset:43008
    s_mov_b64 exec, s[30:31]
    ds_write_b128 v8, v[108:111] offset:43008
    s_mov_b64 exec, -1
    buffer_load_dwordx4 v[96:99], v1, s[4:7], 0 offen offset:768
    buffer_load_dwordx4 v[100:103], v2, s[4:7], 0 offen offset:768
    s_mov_b32 s28, 0x144000
    buffer_load_dwordx4 v[104:107], v5, s[8:11], s28 offen
    s_mov_b64 exec, s[30:31]
    buffer_load_dwordx4 v[108:111], v6, s[8:11], s28 offen
    s_mov_b64 exec, -1
    ds_read_b128 v[20:23], v9 offset:16416
    ds_read_b64_tr_b16 v[36:37], v10 offset:19456
    ds_read_b64_tr_b16 v[38:39], v10 offset:20224
    ds_read_b64_tr_b16 v[40:41], v10 offset:19520
    ds_read_b64_tr_b16 v[42:43], v10 offset:20288
    ds_read_b64_tr_b16 v[44:45], v10 offset:19584
    ds_read_b64_tr_b16 v[46:47], v10 offset:20352
    s_waitcnt lgkmcnt(11)
    v_mfma_f32_32x32x16_bf16 v[48:63], v[16:19], v[24:27], v[48:63]
    v_mfma_f32_32x32x16_bf16 v[64:79], v[16:19], v[28:31], v[64:79]
    v_mfma_f32_32x32x16_bf16 v[80:95], v[16:19], v[32:35], v[80:95]
    s_waitcnt lgkmcnt(0)
    s_barrier
    ds_read_b128 v[16:19], v9 offset:32768
    ds_read_b64_tr_b16 v[24:25], v10 offset:32768
    ds_read_b64_tr_b16 v[26:27], v10 offset:33536
    ds_read_b64_tr_b16 v[28:29], v10 offset:32832
    ds_read_b64_tr_b16 v[30:31], v10 offset:33600
    ds_read_b64_tr_b16 v[32:33], v10 offset:32896
    ds_read_b64_tr_b16 v[34:35], v10 offset:33664
    v_mfma_f32_32x32x16_bf16 v[48:63], v[20:23], v[36:39], v[48:63]
    v_mfma_f32_32x32x16_bf16 v[64:79], v[20:23], v[40:43], v[64:79]
    v_mfma_f32_32x32x16_bf16 v[80:95], v[20:23], v[44:47], v[80:95]
    s_waitcnt vmcnt(12)
    ds_write_b128 v3, v[112:115] offset:0
    ds_write_b128 v4, v[116:119] offset:0
    ds_write_b128 v7, v[120:123] offset:10240
    s_mov_b64 exec, s[30:31]
    ds_write_b128 v8, v[124:127] offset:10240
    s_mov_b64 exec, -1
    buffer_load_dwordx4 v[112:115], v1, s[4:7], 0 offen offset:832
    buffer_load_dwordx4 v[116:119], v2, s[4:7], 0 offen offset:832
    s_mov_b32 s28, 0x15f000
    buffer_load_dwordx4 v[120:123], v5, s[8:11], s28 offen
    s_mov_b64 exec, s[30:31]
    buffer_load_dwordx4 v[124:127], v6, s[8:11], s28 offen
    s_mov_b64 exec, -1
    ds_read_b128 v[20:23], v9 offset:32800
    ds_read_b64_tr_b16 v[36:37], v10 offset:35840
    ds_read_b64_tr_b16 v[38:39], v10 offset:36608
    ds_read_b64_tr_b16 v[40:41], v10 offset:35904
    ds_read_b64_tr_b16 v[42:43], v10 offset:36672
    ds_read_b64_tr_b16 v[44:45], v10 offset:35968
    ds_read_b64_tr_b16 v[46:47], v10 offset:36736
    s_waitcnt lgkmcnt(11)
    v_mfma_f32_32x32x16_bf16 v[48:63], v[16:19], v[24:27], v[48:63]
    v_mfma_f32_32x32x16_bf16 v[64:79], v[16:19], v[28:31], v[64:79]
    v_mfma_f32_32x32x16_bf16 v[80:95], v[16:19], v[32:35], v[80:95]
    s_waitcnt lgkmcnt(0)
    s_barrier
    ds_read_b128 v[16:19], v9 offset:0
    ds_read_b64_tr_b16 v[24:25], v10 offset:0
    ds_read_b64_tr_b16 v[26:27], v10 offset:768
    ds_read_b64_tr_b16 v[28:29], v10 offset:64
    ds_read_b64_tr_b16 v[30:31], v10 offset:832
    ds_read_b64_tr_b16 v[32:33], v10 offset:128
    ds_read_b64_tr_b16 v[34:35], v10 offset:896
    v_mfma_f32_32x32x16_bf16 v[48:63], v[20:23], v[36:39], v[48:63]
    v_mfma_f32_32x32x16_bf16 v[64:79], v[20:23], v[40:43], v[64:79]
    v_mfma_f32_32x32x16_bf16 v[80:95], v[20:23], v[44:47], v[80:95]
    s_waitcnt vmcnt(12)
    ds_write_b128 v3, v[128:131] offset:16384
    ds_write_b128 v4, v[132:135] offset:16384
    ds_write_b128 v7, v[136:139] offset:26624
    s_mov_b64 exec, s[30:31]
    ds_write_b128 v8, v[140:143] offset:26624
    s_mov_b64 exec, -1
    buffer_load_dwordx4 v[128:131], v1, s[4:7], 0 offen offset:896
    buffer_load_dwordx4 v[132:135], v2, s[4:7], 0 offen offset:896
    s_mov_b32 s28, 0x17a000
    buffer_load_dwordx4 v[136:139], v5, s[8:11], s28 offen
    s_mov_b64 exec, s[30:31]
    buffer_load_dwordx4 v[140:143], v6, s[8:11], s28 offen
    s_mov_b64 exec, -1
    ds_read_b128 v[20:23], v9 offset:32
    ds_read_b64_tr_b16 v[36:37], v10 offset:3072
    ds_read_b64_tr_b16 v[38:39], v10 offset:3840
    ds_read_b64_tr_b16 v[40:41], v10 offset:3136
    ds_read_b64_tr_b16 v[42:43], v10 offset:3904
    ds_read_b64_tr_b16 v[44:45], v10 offset:3200
    ds_read_b64_tr_b16 v[46:47], v10 offset:3968
    s_waitcnt lgkmcnt(11)
    v_mfma_f32_32x32x16_bf16 v[48:63], v[16:19], v[24:27], v[48:63]
    v_mfma_f32_32x32x16_bf16 v[64:79], v[16:19], v[28:31], v[64:79]
    v_mfma_f32_32x32x16_bf16 v[80:95], v[16:19], v[32:35], v[80:95]
    s_waitcnt lgkmcnt(0)
    s_barrier
    ds_read_b128 v[16:19], v9 offset:16384
    ds_read_b64_tr_b16 v[24:25], v10 offset:16384
    ds_read_b64_tr_b16 v[26:27], v10 offset:17152
    ds_read_b64_tr_b16 v[28:29], v10 offset:16448
    ds_read_b64_tr_b16 v[30:31], v10 offset:17216
    ds_read_b64_tr_b16 v[32:33], v10 offset:16512
    ds_read_b64_tr_b16 v[34:35], v10 offset:17280
    v_mfma_f32_32x32x16_bf16 v[48:63], v[20:23], v[36:39], v[48:63]
    v_mfma_f32_32x32x16_bf16 v[64:79], v[20:23], v[40:43], v[64:79]
    v_mfma_f32_32x32x16_bf16 v[80:95], v[20:23], v[44:47], v[80:95]
    s_waitcnt vmcnt(12)
    ds_write_b128 v3, v[144:147] offset:32768
    ds_write_b128 v4, v[148:151] offset:32768
    ds_write_b128 v7, v[152:155] offset:43008
    s_mov_b64 exec, s[30:31]
    ds_write_b128 v8, v[156:159] offset:43008
    s_mov_b64 exec, -1
    buffer_load_dwordx4 v[144:147], v1, s[4:7], 0 offen offset:960
    buffer_load_dwordx4 v[148:151], v2, s[4:7], 0 offen offset:960
    s_mov_b32 s28, 0x195000
    buffer_load_dwordx4 v[152:155], v5, s[8:11], s28 offen
    s_mov_b64 exec, s[30:31]
    buffer_load_dwordx4 v[156:159], v6, s[8:11], s28 offen
    s_mov_b64 exec, -1
    ds_read_b128 v[20:23], v9 offset:16416
    ds_read_b64_tr_b16 v[36:37], v10 offset:19456
    ds_read_b64_tr_b16 v[38:39], v10 offset:20224
    ds_read_b64_tr_b16 v[40:41], v10 offset:19520
    ds_read_b64_tr_b16 v[42:43], v10 offset:20288
    ds_read_b64_tr_b16 v[44:45], v10 offset:19584
    ds_read_b64_tr_b16 v[46:47], v10 offset:20352
    s_waitcnt lgkmcnt(11)
    v_mfma_f32_32x32x16_bf16 v[48:63], v[16:19], v[24:27], v[48:63]
    v_mfma_f32_32x32x16_bf16 v[64:79], v[16:19], v[28:31], v[64:79]
    v_mfma_f32_32x32x16_bf16 v[80:95], v[16:19], v[32:35], v[80:95]
    s_waitcnt lgkmcnt(0)
    s_barrier
    ds_read_b128 v[16:19], v9 offset:32768
    ds_read_b64_tr_b16 v[24:25], v10 offset:32768
    ds_read_b64_tr_b16 v[26:27], v10 offset:33536
    ds_read_b64_tr_b16 v[28:29], v10 offset:32832
    ds_read_b64_tr_b16 v[30:31], v10 offset:33600
    ds_read_b64_tr_b16 v[32:33], v10 offset:32896
    ds_read_b64_tr_b16 v[34:35], v10 offset:33664
    v_mfma_f32_32x32x16_bf16 v[48:63], v[20:23], v[36:39], v[48:63]
    v_mfma_f32_32x32x16_bf16 v[64:79], v[20:23], v[40:43], v[64:79]
    v_mfma_f32_32x32x16_bf16 v[80:95], v[20:23], v[44:47], v[80:95]
    s_waitcnt vmcnt(12)
    ds_write_b128 v3, v[96:99] offset:0
    ds_write_b128 v4, v[100:103] offset:0
    ds_write_b128 v7, v[104:107] offset:10240
    s_mov_b64 exec, s[30:31]
    ds_write_b128 v8, v[108:111] offset:10240
    s_mov_b64 exec, -1
    buffer_load_dwordx4 v[96:99], v1, s[4:7], 0 offen offset:1024
    buffer_load_dwordx4 v[100:103], v2, s[4:7], 0 offen offset:1024
    s_mov_b32 s28, 0x1b0000
    buffer_load_dwordx4 v[104:107], v5, s[8:11], s28 offen
    s_mov_b64 exec, s[30:31]
    buffer_load_dwordx4 v[108:111], v6, s[8:11], s28 offen
    s_mov_b64 exec, -1
    ds_read_b128 v[20:23], v9 offset:32800
    ds_read_b64_tr_b16 v[36:37], v10 offset:35840
    ds_read_b64_tr_b16 v[38:39], v10 offset:36608
    ds_read_b64_tr_b16 v[40:41], v10 offset:35904
    ds_read_b64_tr_b16 v[42:43], v10 offset:36672
    ds_read_b64_tr_b16 v[44:45], v10 offset:35968
    ds_read_b64_tr_b16 v[46:47], v10 offset:36736
    s_waitcnt lgkmcnt(11)
    v_mfma_f32_32x32x16_bf16 v[48:63], v[16:19], v[24:27], v[48:63]
    v_mfma_f32_32x32x16_bf16 v[64:79], v[16:19], v[28:31], v[64:79]
    v_mfma_f32_32x32x16_bf16 v[80:95], v[16:19], v[32:35], v[80:95]
    s_waitcnt lgkmcnt(0)
    s_barrier
    ds_read_b128 v[16:19], v9 offset:0
    ds_read_b64_tr_b16 v[24:25], v10 offset:0
    ds_read_b64_tr_b16 v[26:27], v10 offset:768
    ds_read_b64_tr_b16 v[28:29], v10 offset:64
    ds_read_b64_tr_b16 v[30:31], v10 offset:832
    ds_read_b64_tr_b16 v[32:33], v10 offset:128
    ds_read_b64_tr_b16 v[34:35], v10 offset:896
    v_mfma_f32_32x32x16_bf16 v[48:63], v[20:23], v[36:39], v[48:63]
    v_mfma_f32_32x32x16_bf16 v[64:79], v[20:23], v[40:43], v[64:79]
    v_mfma_f32_32x32x16_bf16 v[80:95], v[20:23], v[44:47], v[80:95]
    s_waitcnt vmcnt(12)
    ds_write_b128 v3, v[112:115] offset:16384
    ds_write_b128 v4, v[116:119] offset:16384
    ds_write_b128 v7, v[120:123] offset:26624
    s_mov_b64 exec, s[30:31]
    ds_write_b128 v8, v[124:127] offset:26624
    s_mov_b64 exec, -1
    buffer_load_dwordx4 v[112:115], v1, s[4:7], 0 offen offset:1088
    buffer_load_dwordx4 v[116:119], v2, s[4:7], 0 offen offset:1088
    s_mov_b32 s28, 0x1cb000
    buffer_load_dwordx4 v[120:123], v5, s[8:11], s28 offen
    s_mov_b64 exec, s[30:31]
    buffer_load_dwordx4 v[124:127], v6, s[8:11], s28 offen
    s_mov_b64 exec, -1
    ds_read_b128 v[20:23], v9 offset:32
    ds_read_b64_tr_b16 v[36:37], v10 offset:3072
    ds_read_b64_tr_b16 v[38:39], v10 offset:3840
    ds_read_b64_tr_b16 v[40:41], v10 offset:3136
    ds_read_b64_tr_b16 v[42:43], v10 offset:3904
    ds_read_b64_tr_b16 v[44:45], v10 offset:3200
    ds_read_b64_tr_b16 v[46:47], v10 offset:3968
    s_waitcnt lgkmcnt(11)
    v_mfma_f32_32x32x16_bf16 v[48:63], v[16:19], v[24:27], v[48:63]
    v_mfma_f32_32x32x16_bf16 v[64:79], v[16:19], v[28:31], v[64:79]
    v_mfma_f32_32x32x16_bf16 v[80:95], v[16:19], v[32:35], v[80:95]
    s_waitcnt lgkmcnt(0)
    s_barrier
    ds_read_b128 v[16:19], v9 offset:16384
    ds_read_b64_tr_b16 v[24:25], v10 offset:16384
    ds_read_b64_tr_b16 v[26:27], v10 offset:17152
    ds_read_b64_tr_b16 v[28:29], v10 offset:16448
    ds_read_b64_tr_b16 v[30:31], v10 offset:17216
    ds_read_b64_tr_b16 v[32:33], v10 offset:16512
    ds_read_b64_tr_b16 v[34:35], v10 offset:17280
    v_mfma_f32_32x32x16_bf16 v[48:63], v[20:23], v[36:39], v[48:63]
    v_mfma_f32_32x32x16_bf16 v[64:79], v[20:23], v[40:43], v[64:79]
    v_mfma_f32_32x32x16_bf16 v[80:95], v[20:23], v[44:47], v[80:95]
    s_waitcnt vmcnt(12)
    ds_write_b128 v3, v[128:131] offset:32768
    ds_write_b128 v4, v[132:135] offset:32768
    ds_write_b128 v7, v[136:139] offset:43008
    s_mov_b64 exec, s[30:31]
    ds_write_b128 v8, v[140:143] offset:43008
    s_mov_b64 exec, -1
    ds_read_b128 v[20:23], v9 offset:16416
    ds_read_b64_tr_b16 v[36:37], v10 offset:19456
    ds_read_b64_tr_b16 v[38:39], v10 offset:20224
    ds_read_b64_tr_b16 v[40:41], v10 offset:19520
    ds_read_b64_tr_b16 v[42:43], v10 offset:20288
    ds_read_b64_tr_b16 v[44:45], v10 offset:19584
    ds_read_b64_tr_b16 v[46:47], v10 offset:20352
    s_waitcnt lgkmcnt(11)
    v_mfma_f32_32x32x16_bf16 v[48:63], v[16:19], v[24:27], v[48:63]
    v_mfma_f32_32x32x16_bf16 v[64:79], v[16:19], v[28:31], v[64:79]
    v_mfma_f32_32x32x16_bf16 v[80:95], v[16:19], v[32:35], v[80:95]
    s_waitcnt lgkmcnt(0)
    s_barrier
    ds_read_b128 v[16:19], v9 offset:32768
    ds_read_b64_tr_b16 v[24:25], v10 offset:32768
    ds_read_b64_tr_b16 v[26:27], v10 offset:33536
    ds_read_b64_tr_b16 v[28:29], v10 offset:32832
    ds_read_b64_tr_b16 v[30:31], v10 offset:33600
    ds_read_b64_tr_b16 v[32:33], v10 offset:32896
    ds_read_b64_tr_b16 v[34:35], v10 offset:33664
    v_mfma_f32_32x32x16_bf16 v[48:63], v[20:23], v[36:39], v[48:63]
    v_mfma_f32_32x32x16_bf16 v[64:79], v[20:23], v[40:43], v[64:79]
    v_mfma_f32_32x32x16_bf16 v[80:95], v[20:23], v[44:47], v[80:95]
    s_waitcnt vmcnt(8)
    ds_write_b128 v3, v[144:147] offset:0
    ds_write_b128 v4, v[148:151] offset:0
    ds_write_b128 v7, v[152:155] offset:10240
    s_mov_b64 exec, s[30:31]
    ds_write_b128 v8, v[156:159] offset:10240
    s_mov_b64 exec, -1
    ds_read_b128 v[20:23], v9 offset:32800
    ds_read_b64_tr_b16 v[36:37], v10 offset:35840
    ds_read_b64_tr_b16 v[38:39], v10 offset:36608
    ds_read_b64_tr_b16 v[40:41], v10 offset:35904
    ds_read_b64_tr_b16 v[42:43], v10 offset:36672
    ds_read_b64_tr_b16 v[44:45], v10 offset:35968
    ds_read_b64_tr_b16 v[46:47], v10 offset:36736
    s_waitcnt lgkmcnt(11)
    v_mfma_f32_32x32x16_bf16 v[48:63], v[16:19], v[24:27], v[48:63]
    v_mfma_f32_32x32x16_bf16 v[64:79], v[16:19], v[28:31], v[64:79]
    v_mfma_f32_32x32x16_bf16 v[80:95], v[16:19], v[32:35], v[80:95]
    s_waitcnt lgkmcnt(0)
    s_barrier
    ds_read_b128 v[16:19], v9 offset:0
    ds_read_b64_tr_b16 v[24:25], v10 offset:0
    ds_read_b64_tr_b16 v[26:27], v10 offset:768
    ds_read_b64_tr_b16 v[28:29], v10 offset:64
    ds_read_b64_tr_b16 v[30:31], v10 offset:832
    ds_read_b64_tr_b16 v[32:33], v10 offset:128
    ds_read_b64_tr_b16 v[34:35], v10 offset:896
    v_mfma_f32_32x32x16_bf16 v[48:63], v[20:23], v[36:39], v[48:63]
    v_mfma_f32_32x32x16_bf16 v[64:79], v[20:23], v[40:43], v[64:79]
    v_mfma_f32_32x32x16_bf16 v[80:95], v[20:23], v[44:47], v[80:95]
    s_waitcnt vmcnt(4)
    ds_write_b128 v3, v[96:99] offset:16384
    ds_write_b128 v4, v[100:103] offset:16384
    ds_write_b128 v7, v[104:107] offset:26624
    s_mov_b64 exec, s[30:31]
    ds_write_b128 v8, v[108:111] offset:26624
    s_mov_b64 exec, -1
    ds_read_b128 v[20:23], v9 offset:32
    ds_read_b64_tr_b16 v[36:37], v10 offset:3072
    ds_read_b64_tr_b16 v[38:39], v10 offset:3840
    ds_read_b64_tr_b16 v[40:41], v10 offset:3136
    ds_read_b64_tr_b16 v[42:43], v10 offset:3904
    ds_read_b64_tr_b16 v[44:45], v10 offset:3200
    ds_read_b64_tr_b16 v[46:47], v10 offset:3968
    s_waitcnt lgkmcnt(11)
    v_mfma_f32_32x32x16_bf16 v[48:63], v[16:19], v[24:27], v[48:63]
    v_mfma_f32_32x32x16_bf16 v[64:79], v[16:19], v[28:31], v[64:79]
    v_mfma_f32_32x32x16_bf16 v[80:95], v[16:19], v[32:35], v[80:95]
    s_waitcnt lgkmcnt(0)
    s_barrier
    ds_read_b128 v[16:19], v9 offset:16384
    ds_read_b64_tr_b16 v[24:25], v10 offset:16384
    ds_read_b64_tr_b16 v[26:27], v10 offset:17152
    ds_read_b64_tr_b16 v[28:29], v10 offset:16448
    ds_read_b64_tr_b16 v[30:31], v10 offset:17216
    ds_read_b64_tr_b16 v[32:33], v10 offset:16512
    ds_read_b64_tr_b16 v[34:35], v10 offset:17280
    v_mfma_f32_32x32x16_bf16 v[48:63], v[20:23], v[36:39], v[48:63]
    v_mfma_f32_32x32x16_bf16 v[64:79], v[20:23], v[40:43], v[64:79]
    v_mfma_f32_32x32x16_bf16 v[80:95], v[20:23], v[44:47], v[80:95]
    s_waitcnt vmcnt(0)
    ds_write_b128 v3, v[112:115] offset:32768
    ds_write_b128 v4, v[116:119] offset:32768
    ds_write_b128 v7, v[120:123] offset:43008
    s_mov_b64 exec, s[30:31]
    ds_write_b128 v8, v[124:127] offset:43008
    s_mov_b64 exec, -1
    ds_read_b128 v[20:23], v9 offset:16416
    ds_read_b64_tr_b16 v[36:37], v10 offset:19456
    ds_read_b64_tr_b16 v[38:39], v10 offset:20224
    ds_read_b64_tr_b16 v[40:41], v10 offset:19520
    ds_read_b64_tr_b16 v[42:43], v10 offset:20288
    ds_read_b64_tr_b16 v[44:45], v10 offset:19584
    ds_read_b64_tr_b16 v[46:47], v10 offset:20352
    s_waitcnt lgkmcnt(11)
    v_mfma_f32_32x32x16_bf16 v[48:63], v[16:19], v[24:27], v[48:63]
    v_mfma_f32_32x32x16_bf16 v[64:79], v[16:19], v[28:31], v[64:79]
    v_mfma_f32_32x32x16_bf16 v[80:95], v[16:19], v[32:35], v[80:95]
    s_waitcnt lgkmcnt(0)
    s_barrier
    ds_read_b128 v[16:19], v9 offset:32768
    ds_read_b64_tr_b16 v[24:25], v10 offset:32768
    ds_read_b64_tr_b16 v[26:27], v10 offset:33536
    ds_read_b64_tr_b16 v[28:29], v10 offset:32832
    ds_read_b64_tr_b16 v[30:31], v10 offset:33600
    ds_read_b64_tr_b16 v[32:33], v10 offset:32896
    ds_read_b64_tr_b16 v[34:35], v10 offset:33664
    v_mfma_f32_32x32x16_bf16 v[48:63], v[20:23], v[36:39], v[48:63]
    v_mfma_f32_32x32x16_bf16 v[64:79], v[20:23], v[40:43], v[64:79]
    v_mfma_f32_32x32x16_bf16 v[80:95], v[20:23], v[44:47], v[80:95]
    ds_read_b128 v[20:23], v9 offset:32800
    ds_read_b64_tr_b16 v[36:37], v10 offset:35840
    ds_read_b64_tr_b16 v[38:39], v10 offset:36608
    ds_read_b64_tr_b16 v[40:41], v10 offset:35904
    ds_read_b64_tr_b16 v[42:43], v10 offset:36672
    ds_read_b64_tr_b16 v[44:45], v10 offset:35968
    ds_read_b64_tr_b16 v[46:47], v10 offset:36736
    s_waitcnt lgkmcnt(7)
    v_mfma_f32_32x32x16_bf16 v[48:63], v[16:19], v[24:27], v[48:63]
    v_mfma_f32_32x32x16_bf16 v[64:79], v[16:19], v[28:31], v[64:79]
    v_mfma_f32_32x32x16_bf16 v[80:95], v[16:19], v[32:35], v[80:95]
    s_waitcnt lgkmcnt(0)
    v_mfma_f32_32x32x16_bf16 v[48:63], v[20:23], v[36:39], v[48:63]
    v_mfma_f32_32x32x16_bf16 v[64:79], v[20:23], v[40:43], v[64:79]
    v_mfma_f32_32x32x16_bf16 v[80:95], v[20:23], v[44:47], v[80:95]
    v_lshrrev_b32 v11, 6, v0
    v_mov_b32 v12, v11
    v_mov_b32 v11, 0
    v_mul_u32_u24 v11, 96, v11
    v_and_b32 v13, 31, v0
    v_add3_u32 v11, v11, v13, s27
    v_lshlrev_b32 v11, 12, v11
    v_mul_u32_u24 v12, 32, v12
    v_bfe_u32 v13, v0, 5, 1
    v_lshl_add_u32 v12, v13, 3, v12
    v_add_u32 v12, s26, v12
    v_lshl_add_u32 v11, v12, 1, v11
    v_cvt_pk_bf16_f32 v48, v48, v49
    v_cvt_pk_bf16_f32 v49, v50, v51
    v_cvt_pk_bf16_f32 v50, v52, v53
    v_cvt_pk_bf16_f32 v51, v54, v55
    v_cvt_pk_bf16_f32 v52, v56, v57
    v_cvt_pk_bf16_f32 v53, v58, v59
    v_cvt_pk_bf16_f32 v54, v60, v61
    v_cvt_pk_bf16_f32 v55, v62, v63
    s_mov_b32 s29, 0x0
    buffer_store_dwordx4 v[48:51], v11, s[12:15], s29 offen offset:0
    buffer_store_dwordx4 v[52:55], v11, s[12:15], s29 offen offset:32
    v_cvt_pk_bf16_f32 v64, v64, v65
    v_cvt_pk_bf16_f32 v65, v66, v67
    v_cvt_pk_bf16_f32 v66, v68, v69
    v_cvt_pk_bf16_f32 v67, v70, v71
    v_cvt_pk_bf16_f32 v68, v72, v73
    v_cvt_pk_bf16_f32 v69, v74, v75
    v_cvt_pk_bf16_f32 v70, v76, v77
    v_cvt_pk_bf16_f32 v71, v78, v79
    s_mov_b32 s29, 0x20000
    buffer_store_dwordx4 v[64:67], v11, s[12:15], s29 offen offset:0
    buffer_store_dwordx4 v[68:71], v11, s[12:15], s29 offen offset:32
    v_cvt_pk_bf16_f32 v80, v80, v81
    v_cvt_pk_bf16_f32 v81, v82, v83
    v_cvt_pk_bf16_f32 v82, v84, v85
    v_cvt_pk_bf16_f32 v83, v86, v87
    v_cvt_pk_bf16_f32 v84, v88, v89
    v_cvt_pk_bf16_f32 v85, v90, v91
    v_cvt_pk_bf16_f32 v86, v92, v93
    v_cvt_pk_bf16_f32 v87, v94, v95
    s_mov_b32 s29, 0x40000
    buffer_store_dwordx4 v[80:83], v11, s[12:15], s29 offen offset:0
    buffer_store_dwordx4 v[84:87], v11, s[12:15], s29 offen offset:32
    s_endpgm
PREP_2:
    s_cmp_ge_u32 s2, 336
    s_cbranch_scc1 KGEN_3
    s_sub_u32 s3, s2, 240
    s_load_dwordx2 s[20:21], s[0:1], 0
    s_load_dwordx2 s[22:23], s[0:1], 80
    s_load_dwordx2 s[24:25], s[0:1], 104
    v_lshrrev_b32 v1, 6, v0
    s_nop 0
    v_readfirstlane_b32 s26, v1
    s_lshr_b32 s17, s3, 5
    s_and_b32 s16, s3, 31
    s_lshl_b32 s16, s16, 6
    s_mul_i32 s27, s26, 96
    s_mul_i32 s18, s17, 384
    s_add_u32 s27, s27, s18
    s_waitcnt lgkmcnt(0)
    s_mov_b32 s4, s20
    s_mov_b32 s5, s21
    s_mov_b32 s6, 0x240000
    s_mov_b32 s7, 0x00020000
    s_add_u32 s8, s24, 0xc00000
    s_addc_u32 s9, s25, 0
    s_mov_b32 s10, 0x240000
    s_mov_b32 s11, 0x00020000
    s_add_u32 s12, s24, 0x1010000
    s_addc_u32 s13, s25, 0
    s_mov_b32 s14, 0x6000
    s_mov_b32 s15, 0x00020000
    s_add_u32 s22, s22, s27
    s_addc_u32 s23, s23, 0
    s_load_dwordx8 s[28:35], s[22:23], 0
    s_load_dwordx8 s[36:43], s[22:23], 32
    s_load_dwordx8 s[44:51], s[22:23], 64
    v_and_b32 v1, 63, v0
    v_add_u32 v1, s16, v1
    v_mul_u32_u24 v2, 1152, v1
    v_add_u32 v2, s27, v2
    buffer_load_dwordx4 v[16:19], v2, s[4:7], 0 offen offset:0
    buffer_load_dwordx4 v[20:23], v2, s[4:7], 0 offen offset:16
    buffer_load_dwordx4 v[24:27], v2, s[4:7], 0 offen offset:32
    buffer_load_dwordx4 v[28:31], v2, s[4:7], 0 offen offset:48
    buffer_load_dwordx4 v[32:35], v2, s[4:7], 0 offen offset:64
    buffer_load_dwordx4 v[36:39], v2, s[4:7], 0 offen offset:80
    s_lshl_b32 s19, s27, 11
    v_lshlrev_b32 v3, 1, v1
    v_add_u32 v3, s19, v3
    v_mov_b32 v4, 0
    s_waitcnt lgkmcnt(0)
    s_waitcnt vmcnt(5)
    s_mov_b32 s18, 0x0
    buffer_store_short v16, v3, s[8:11], s18 offen
    s_mov_b32 s19, 0x1000
    buffer_store_short_d16_hi v16, v3, s[8:11], s19 offen
    v_lshlrev_b32 v5, 16, v16
    v_and_b32 v6, 0xffff0000, v16
    s_lshl_b32 s18, s28, 16
    s_and_b32 s19, s28, 0xffff0000
    v_mul_f32 v5, s18, v5
    v_mul_f32 v6, s19, v6
    v_cvt_pk_bf16_f32 v7, v5, v6
    v_lshlrev_b32 v5, 16, v7
    v_and_b32 v6, 0xffff0000, v7
    v_add_f32 v4, v4, v5
    v_add_f32 v4, v4, v6
    s_mov_b32 s18, 0x2000
    buffer_store_short v17, v3, s[8:11], s18 offen
    s_mov_b32 s19, 0x3000
    buffer_store_short_d16_hi v17, v3, s[8:11], s19 offen
    v_lshlrev_b32 v5, 16, v17
    v_and_b32 v6, 0xffff0000, v17
    s_lshl_b32 s18, s29, 16
    s_and_b32 s19, s29, 0xffff0000
    v_mul_f32 v5, s18, v5
    v_mul_f32 v6, s19, v6
    v_cvt_pk_bf16_f32 v7, v5, v6
    v_lshlrev_b32 v5, 16, v7
    v_and_b32 v6, 0xffff0000, v7
    v_add_f32 v4, v4, v5
    v_add_f32 v4, v4, v6
    s_mov_b32 s18, 0x4000
    buffer_store_short v18, v3, s[8:11], s18 offen
    s_mov_b32 s19, 0x5000
    buffer_store_short_d16_hi v18, v3, s[8:11], s19 offen
    v_lshlrev_b32 v5, 16, v18
    v_and_b32 v6, 0xffff0000, v18
    s_lshl_b32 s18, s30, 16
    s_and_b32 s19, s30, 0xffff0000
    v_mul_f32 v5, s18, v5
    v_mul_f32 v6, s19, v6
    v_cvt_pk_bf16_f32 v7, v5, v6
    v_lshlrev_b32 v5, 16, v7
    v_and_b32 v6, 0xffff0000, v7
    v_add_f32 v4, v4, v5
    v_add_f32 v4, v4, v6
    s_mov_b32 s18, 0x6000
    buffer_store_short v19, v3, s[8:11], s18 offen
    s_mov_b32 s19, 0x7000
    buffer_store_short_d16_hi v19, v3, s[8:11], s19 offen
    v_lshlrev_b32 v5, 16, v19
    v_and_b32 v6, 0xffff0000, v19
    s_lshl_b32 s18, s31, 16
    s_and_b32 s19, s31, 0xffff0000
    v_mul_f32 v5, s18, v5
    v_mul_f32 v6, s19, v6
    v_cvt_pk_bf16_f32 v7, v5, v6
    v_lshlrev_b32 v5, 16, v7
    v_and_b32 v6, 0xffff0000, v7
    v_add_f32 v4, v4, v5
    v_add_f32 v4, v4, v6
    s_waitcnt vmcnt(4)
    s_mov_b32 s18, 0x8000
    buffer_store_short v20, v3, s[8:11], s18 offen
    s_mov_b32 s19, 0x9000
    buffer_store_short_d16_hi v20, v3, s[8:11], s19 offen
    v_lshlrev_b32 v5, 16, v20
    v_and_b32 v6, 0xffff0000, v20
    s_lshl_b32 s18, s32, 16
    s_and_b32 s19, s32, 0xffff0000
    v_mul_f32 v5, s18, v5
    v_mul_f32 v6, s19, v6
    v_cvt_pk_bf16_f32 v7, v5, v6
    v_lshlrev_b32 v5, 16, v7
    v_and_b32 v6, 0xffff0000, v7
    v_add_f32 v4, v4, v5
    v_add_f32 v4, v4, v6
    s_mov_b32 s18, 0xa000
    buffer_store_short v21, v3, s[8:11], s18 offen
    s_mov_b32 s19, 0xb000
    buffer_store_short_d16_hi v21, v3, s[8:11], s19 offen
    v_lshlrev_b32 v5, 16, v21
    v_and_b32 v6, 0xffff0000, v21
    s_lshl_b32 s18, s33, 16
    s_and_b32 s19, s33, 0xffff0000
    v_mul_f32 v5, s18, v5
    v_mul_f32 v6, s19, v6
    v_cvt_pk_bf16_f32 v7, v5, v6
    v_lshlrev_b32 v5, 16, v7
    v_and_b32 v6, 0xffff0000, v7
    v_add_f32 v4, v4, v5
    v_add_f32 v4, v4, v6
    s_mov_b32 s18, 0xc000
    buffer_store_short v22, v3, s[8:11], s18 offen
    s_mov_b32 s19, 0xd000
    buffer_store_short_d16_hi v22, v3, s[8:11], s19 offen
    v_lshlrev_b32 v5, 16, v22
    v_and_b32 v6, 0xffff0000, v22
    s_lshl_b32 s18, s34, 16
    s_and_b32 s19, s34, 0xffff0000
    v_mul_f32 v5, s18, v5
    v_mul_f32 v6, s19, v6
    v_cvt_pk_bf16_f32 v7, v5, v6
    v_lshlrev_b32 v5, 16, v7
    v_and_b32 v6, 0xffff0000, v7
    v_add_f32 v4, v4, v5
    v_add_f32 v4, v4, v6
    s_mov_b32 s18, 0xe000
    buffer_store_short v23, v3, s[8:11], s18 offen
    s_mov_b32 s19, 0xf000
    buffer_store_short_d16_hi v23, v3, s[8:11], s19 offen
    v_lshlrev_b32 v5, 16, v23
    v_and_b32 v6, 0xffff0000, v23
    s_lshl_b32 s18, s35, 16
    s_and_b32 s19, s35, 0xffff0000
    v_mul_f32 v5, s18, v5
    v_mul_f32 v6, s19, v6
    v_cvt_pk_bf16_f32 v7, v5, v6
    v_lshlrev_b32 v5, 16, v7
    v_and_b32 v6, 0xffff0000, v7
    v_add_f32 v4, v4, v5
    v_add_f32 v4, v4, v6
    s_waitcnt vmcnt(3)
    s_mov_b32 s18, 0x10000
    buffer_store_short v24, v3, s[8:11], s18 offen
    s_mov_b32 s19, 0x11000
    buffer_store_short_d16_hi v24, v3, s[8:11], s19 offen
    v_lshlrev_b32 v5, 16, v24
    v_and_b32 v6, 0xffff0000, v24
    s_lshl_b32 s18, s36, 16
    s_and_b32 s19, s36, 0xffff0000
    v_mul_f32 v5, s18, v5
    v_mul_f32 v6, s19, v6
    v_cvt_pk_bf16_f32 v7, v5, v6
    v_lshlrev_b32 v5, 16, v7
    v_and_b32 v6, 0xffff0000, v7
    v_add_f32 v4, v4, v5
    v_add_f32 v4, v4, v6
    s_mov_b32 s18, 0x12000
    buffer_store_short v25, v3, s[8:11], s18 offen
    s_mov_b32 s19, 0x13000
    buffer_store_short_d16_hi v25, v3, s[8:11], s19 offen
    v_lshlrev_b32 v5, 16, v25
    v_and_b32 v6, 0xffff0000, v25
    s_lshl_b32 s18, s37, 16
    s_and_b32 s19, s37, 0xffff0000
    v_mul_f32 v5, s18, v5
    v_mul_f32 v6, s19, v6
    v_cvt_pk_bf16_f32 v7, v5, v6
    v_lshlrev_b32 v5, 16, v7
    v_and_b32 v6, 0xffff0000, v7
    v_add_f32 v4, v4, v5
    v_add_f32 v4, v4, v6
    s_mov_b32 s18, 0x14000
    buffer_store_short v26, v3, s[8:11], s18 offen
    s_mov_b32 s19, 0x15000
    buffer_store_short_d16_hi v26, v3, s[8:11], s19 offen
    v_lshlrev_b32 v5, 16, v26
    v_and_b32 v6, 0xffff0000, v26
    s_lshl_b32 s18, s38, 16
    s_and_b32 s19, s38, 0xffff0000
    v_mul_f32 v5, s18, v5
    v_mul_f32 v6, s19, v6
    v_cvt_pk_bf16_f32 v7, v5, v6
    v_lshlrev_b32 v5, 16, v7
    v_and_b32 v6, 0xffff0000, v7
    v_add_f32 v4, v4, v5
    v_add_f32 v4, v4, v6
    s_mov_b32 s18, 0x16000
    buffer_store_short v27, v3, s[8:11], s18 offen
    s_mov_b32 s19, 0x17000
    buffer_store_short_d16_hi v27, v3, s[8:11], s19 offen
    v_lshlrev_b32 v5, 16, v27
    v_and_b32 v6, 0xffff0000, v27
    s_lshl_b32 s18, s39, 16
    s_and_b32 s19, s39, 0xffff0000
    v_mul_f32 v5, s18, v5
    v_mul_f32 v6, s19, v6
    v_cvt_pk_bf16_f32 v7, v5, v6
    v_lshlrev_b32 v5, 16, v7
    v_and_b32 v6, 0xffff0000, v7
    v_add_f32 v4, v4, v5
    v_add_f32 v4, v4, v6
    s_waitcnt vmcnt(2)
    s_mov_b32 s18, 0x18000
    buffer_store_short v28, v3, s[8:11], s18 offen
    s_mov_b32 s19, 0x19000
    buffer_store_short_d16_hi v28, v3, s[8:11], s19 offen
    v_lshlrev_b32 v5, 16, v28
    v_and_b32 v6, 0xffff0000, v28
    s_lshl_b32 s18, s40, 16
    s_and_b32 s19, s40, 0xffff0000
    v_mul_f32 v5, s18, v5
    v_mul_f32 v6, s19, v6
    v_cvt_pk_bf16_f32 v7, v5, v6
    v_lshlrev_b32 v5, 16, v7
    v_and_b32 v6, 0xffff0000, v7
    v_add_f32 v4, v4, v5
    v_add_f32 v4, v4, v6
    s_mov_b32 s18, 0x1a000
    buffer_store_short v29, v3, s[8:11], s18 offen
    s_mov_b32 s19, 0x1b000
    buffer_store_short_d16_hi v29, v3, s[8:11], s19 offen
    v_lshlrev_b32 v5, 16, v29
    v_and_b32 v6, 0xffff0000, v29
    s_lshl_b32 s18, s41, 16
    s_and_b32 s19, s41, 0xffff0000
    v_mul_f32 v5, s18, v5
    v_mul_f32 v6, s19, v6
    v_cvt_pk_bf16_f32 v7, v5, v6
    v_lshlrev_b32 v5, 16, v7
    v_and_b32 v6, 0xffff0000, v7
    v_add_f32 v4, v4, v5
    v_add_f32 v4, v4, v6
    s_mov_b32 s18, 0x1c000
    buffer_store_short v30, v3, s[8:11], s18 offen
    s_mov_b32 s19, 0x1d000
    buffer_store_short_d16_hi v30, v3, s[8:11], s19 offen
    v_lshlrev_b32 v5, 16, v30
    v_and_b32 v6, 0xffff0000, v30
    s_lshl_b32 s18, s42, 16
    s_and_b32 s19, s42, 0xffff0000
    v_mul_f32 v5, s18, v5
    v_mul_f32 v6, s19, v6
    v_cvt_pk_bf16_f32 v7, v5, v6
    v_lshlrev_b32 v5, 16, v7
    v_and_b32 v6, 0xffff0000, v7
    v_add_f32 v4, v4, v5
    v_add_f32 v4, v4, v6
    s_mov_b32 s18, 0x1e000
    buffer_store_short v31, v3, s[8:11], s18 offen
    s_mov_b32 s19, 0x1f000
    buffer_store_short_d16_hi v31, v3, s[8:11], s19 offen
    v_lshlrev_b32 v5, 16, v31
    v_and_b32 v6, 0xffff0000, v31
    s_lshl_b32 s18, s43, 16
    s_and_b32 s19, s43, 0xffff0000
    v_mul_f32 v5, s18, v5
    v_mul_f32 v6, s19, v6
    v_cvt_pk_bf16_f32 v7, v5, v6
    v_lshlrev_b32 v5, 16, v7
    v_and_b32 v6, 0xffff0000, v7
    v_add_f32 v4, v4, v5
    v_add_f32 v4, v4, v6
    s_waitcnt vmcnt(1)
    s_mov_b32 s18, 0x20000
    buffer_store_short v32, v3, s[8:11], s18 offen
    s_mov_b32 s19, 0x21000
    buffer_store_short_d16_hi v32, v3, s[8:11], s19 offen
    v_lshlrev_b32 v5, 16, v32
    v_and_b32 v6, 0xffff0000, v32
    s_lshl_b32 s18, s44, 16
    s_and_b32 s19, s44, 0xffff0000
    v_mul_f32 v5, s18, v5
    v_mul_f32 v6, s19, v6
    v_cvt_pk_bf16_f32 v7, v5, v6
    v_lshlrev_b32 v5, 16, v7
    v_and_b32 v6, 0xffff0000, v7
    v_add_f32 v4, v4, v5
    v_add_f32 v4, v4, v6
    s_mov_b32 s18, 0x22000
    buffer_store_short v33, v3, s[8:11], s18 offen
    s_mov_b32 s19, 0x23000
    buffer_store_short_d16_hi v33, v3, s[8:11], s19 offen
    v_lshlrev_b32 v5, 16, v33
    v_and_b32 v6, 0xffff0000, v33
    s_lshl_b32 s18, s45, 16
    s_and_b32 s19, s45, 0xffff0000
    v_mul_f32 v5, s18, v5
    v_mul_f32 v6, s19, v6
    v_cvt_pk_bf16_f32 v7, v5, v6
    v_lshlrev_b32 v5, 16, v7
    v_and_b32 v6, 0xffff0000, v7
    v_add_f32 v4, v4, v5
    v_add_f32 v4, v4, v6
    s_mov_b32 s18, 0x24000
    buffer_store_short v34, v3, s[8:11], s18 offen
    s_mov_b32 s19, 0x25000
    buffer_store_short_d16_hi v34, v3, s[8:11], s19 offen
    v_lshlrev_b32 v5, 16, v34
    v_and_b32 v6, 0xffff0000, v34
    s_lshl_b32 s18, s46, 16
    s_and_b32 s19, s46, 0xffff0000
    v_mul_f32 v5, s18, v5
    v_mul_f32 v6, s19, v6
    v_cvt_pk_bf16_f32 v7, v5, v6
    v_lshlrev_b32 v5, 16, v7
    v_and_b32 v6, 0xffff0000, v7
    v_add_f32 v4, v4, v5
    v_add_f32 v4, v4, v6
    s_mov_b32 s18, 0x26000
    buffer_store_short v35, v3, s[8:11], s18 offen
    s_mov_b32 s19, 0x27000
    buffer_store_short_d16_hi v35, v3, s[8:11], s19 offen
    v_lshlrev_b32 v5, 16, v35
    v_and_b32 v6, 0xffff0000, v35
    s_lshl_b32 s18, s47, 16
    s_and_b32 s19, s47, 0xffff0000
    v_mul_f32 v5, s18, v5
    v_mul_f32 v6, s19, v6
    v_cvt_pk_bf16_f32 v7, v5, v6
    v_lshlrev_b32 v5, 16, v7
    v_and_b32 v6, 0xffff0000, v7
    v_add_f32 v4, v4, v5
    v_add_f32 v4, v4, v6
    s_waitcnt vmcnt(0)
    s_mov_b32 s18, 0x28000
    buffer_store_short v36, v3, s[8:11], s18 offen
    s_mov_b32 s19, 0x29000
    buffer_store_short_d16_hi v36, v3, s[8:11], s19 offen
    v_lshlrev_b32 v5, 16, v36
    v_and_b32 v6, 0xffff0000, v36
    s_lshl_b32 s18, s48, 16
    s_and_b32 s19, s48, 0xffff0000
    v_mul_f32 v5, s18, v5
    v_mul_f32 v6, s19, v6
    v_cvt_pk_bf16_f32 v7, v5, v6
    v_lshlrev_b32 v5, 16, v7
    v_and_b32 v6, 0xffff0000, v7
    v_add_f32 v4, v4, v5
    v_add_f32 v4, v4, v6
    s_mov_b32 s18, 0x2a000
    buffer_store_short v37, v3, s[8:11], s18 offen
    s_mov_b32 s19, 0x2b000
    buffer_store_short_d16_hi v37, v3, s[8:11], s19 offen
    v_lshlrev_b32 v5, 16, v37
    v_and_b32 v6, 0xffff0000, v37
    s_lshl_b32 s18, s49, 16
    s_and_b32 s19, s49, 0xffff0000
    v_mul_f32 v5, s18, v5
    v_mul_f32 v6, s19, v6
    v_cvt_pk_bf16_f32 v7, v5, v6
    v_lshlrev_b32 v5, 16, v7
    v_and_b32 v6, 0xffff0000, v7
    v_add_f32 v4, v4, v5
    v_add_f32 v4, v4, v6
    s_mov_b32 s18, 0x2c000
    buffer_store_short v38, v3, s[8:11], s18 offen
    s_mov_b32 s19, 0x2d000
    buffer_store_short_d16_hi v38, v3, s[8:11], s19 offen
    v_lshlrev_b32 v5, 16, v38
    v_and_b32 v6, 0xffff0000, v38
    s_lshl_b32 s18, s50, 16
    s_and_b32 s19, s50, 0xffff0000
    v_mul_f32 v5, s18, v5
    v_mul_f32 v6, s19, v6
    v_cvt_pk_bf16_f32 v7, v5, v6
    v_lshlrev_b32 v5, 16, v7
    v_and_b32 v6, 0xffff0000, v7
    v_add_f32 v4, v4, v5
    v_add_f32 v4, v4, v6
    s_mov_b32 s18, 0x2e000
    buffer_store_short v39, v3, s[8:11], s18 offen
    s_mov_b32 s19, 0x2f000
    buffer_store_short_d16_hi v39, v3, s[8:11], s19 offen
    v_lshlrev_b32 v5, 16, v39
    v_and_b32 v6, 0xffff0000, v39
    s_lshl_b32 s18, s51, 16
    s_and_b32 s19, s51, 0xffff0000
    v_mul_f32 v5, s18, v5
    v_mul_f32 v6, s19, v6
    v_cvt_pk_bf16_f32 v7, v5, v6
    v_lshlrev_b32 v5, 16, v7
    v_and_b32 v6, 0xffff0000, v7
    v_add_f32 v4, v4, v5
    v_add_f32 v4, v4, v6
    v_lshlrev_b32 v5, 2, v0
    ds_write_b32 v5, v4
    s_waitcnt lgkmcnt(0)
    s_barrier
    s_cmp_lg_u32 s26, 0
    s_cbranch_scc1 PREPX_5
    ds_read_b32 v6, v5
    ds_read_b32 v7, v5 offset:256
    ds_read_b32 v8, v5 offset:512
    ds_read_b32 v9, v5 offset:768
    s_waitcnt lgkmcnt(0)
    v_add_f32 v6, v6, v7
    v_add_f32 v8, v8, v9
    v_add_f32 v6, v6, v8
    v_lshlrev_b32 v7, 2, v1
    s_lshl_b32 s17, s17, 13
    buffer_store_dword v6, v7, s[12:15], s17 offen
PREPX_5:
    s_waitcnt vmcnt(0)
    s_endpgm
KGEN_3:
    s_cmp_ge_u32 s2, 480
    s_cbranch_scc1 END_1
    s_sub_u32 s3, s2, 336
    s_load_dwordx8 s[20:27], s[0:1], 32
    s_load_dwordx2 s[28:29], s[0:1], 64
    s_load_dwordx2 s[30:31], s[0:1], 104
    v_lshrrev_b32 v3, 6, v0
    s_nop 0
    v_readfirstlane_b32 s40, v3
    s_lshl_b32 s41, s3, 2
    s_add_u32 s41, s41, s40
    s_waitcnt lgkmcnt(0)
    s_mov_b32 s4, s20
    s_mov_b32 s5, s21
    s_mov_b32 s6, 0x24000
    s_mov_b32 s7, 0x00020000
    s_mov_b32 s8, s22
    s_mov_b32 s9, s23
    s_mov_b32 s10, 0x24000
    s_mov_b32 s11, 0x00020000
    s_mov_b32 s12, s24
    s_mov_b32 s13, s25
    s_mov_b32 s14, 0x24000
    s_mov_b32 s15, 0x00020000
    s_mov_b32 s16, s26
    s_mov_b32 s17, s27
    s_mov_b32 s18, 0x24000
    s_mov_b32 s19, 0x00020000
    s_lshr_b32 s32, s41, 1
    s_lshl_b32 s32, s32, 2
    s_load_dword s33, s[28:29], s32
    v_and_b32 v1, 15, v0
    v_bfe_u32 v2, v0, 4, 2
    v_and_b32 v13, 63, v0
    v_lshlrev_b32 v4, 2, v13
    s_lshl_b32 s34, s41, 8
    v_add_u32 v4, s34, v4
    buffer_load_dword v80, v4, s[4:7], 0 offen
    buffer_load_dword v81, v4, s[8:11], 0 offen
    buffer_load_dword v82, v4, s[12:15], 0 offen
    buffer_load_dword v83, v4, s[16:19], 0 offen
    v_lshrrev_b32 v5, 3, v1
    v_lshlrev_b32 v5, 7, v5
    v_and_b32 v6, 7, v1
    v_add_u32 v5, v5, v6
    v_cvt_f32_u32 v8, v5
    v_lshrrev_b32 v5, 2, v1
    v_add_u32 v5, 2, v5
    v_lshlrev_b32 v5, 7, v5
    v_and_b32 v6, 3, v1
    v_lshl_add_u32 v5, v6, 1, v5
    v_lshrrev_b32 v6, 1, v1
    v_lshlrev_b32 v6, 7, v6
    v_and_b32 v7, 1, v1
    v_lshl_add_u32 v6, v7, 2, v6
    v_cmp_gt_u32 vcc, 8, v1
    s_nop 1
    v_cndmask_b32 v5, v6, v5, vcc
    v_cvt_f32_u32 v9, v5
    v_add_u32 v5, 8, v1
    v_lshlrev_b32 v5, 7, v5
    v_cmp_ge_u32 vcc, 8, v1
    s_nop 1
    v_cndmask_b32 v5, 0, v5, vcc
    v_cvt_f32_u32 v10, v5
    v_lshlrev_b32 v5, 3, v1
    v_cvt_f32_u32 v11, v5
    v_mov_b32 v48, 0
    v_mov_b32 v49, 0
    v_mov_b32 v50, 0
    v_mov_b32 v51, 0
    v_mov_b32 v52, 0
    v_mov_b32 v53, 0
    v_mov_b32 v54, 0
    v_mov_b32 v55, 0
    v_mov_b32 v56, 0
    v_mov_b32 v57, 0
    v_mov_b32 v58, 0
    v_mov_b32 v59, 0
    s_waitcnt lgkmcnt(0)
    s_and_b32 s35, s41, 1
    s_lshl_b32 s36, s33, 16
    s_and_b32 s37, s33, 0xffff0000
    s_cmp_eq_u32 s35, 0
    s_cselect_b32 s36, s36, s37
    v_mov_b32 v12, 0x3fb8aa3b
    v_mul_f32 v12, s36, v12
    v_exp_f32 v12, v12
    s_nop 0
    v_cvt_pk_bf16_f32 v12, v12, v12
    v_lshlrev_b32 v12, 16, v12
    s_waitcnt vmcnt(0)
    v_lshlrev_b32 v64, 16, v80
    v_lshlrev_b32 v65, 16, v81
    v_lshlrev_b32 v66, 16, v82
    v_lshlrev_b32 v67, 16, v83
    v_mul_f32 v64, 0x3fb8aa3b, v64
    v_mul_f32 v65, v65, v12
    v_exp_f32 v64, v64
    v_mul_f32 v65, 0x3e22f983, v65
    v_mul_f32 v66, v66, v12
    v_mul_f32 v67, v67, v12
    v_cvt_pk_bf16_f32 v64, v64, v64
    v_lshlrev_b32 v64, 16, v64
    v_mul_f32 v64, v64, v12
    v_mul_f32 v64, 0xbfb8aa3b, v64
    v_and_b32 v68, 0xffff0000, v80
    v_and_b32 v69, 0xffff0000, v81
    v_and_b32 v70, 0xffff0000, v82
    v_and_b32 v71, 0xffff0000, v83
    v_mul_f32 v68, 0x3fb8aa3b, v68
    v_mul_f32 v69, v69, v12
    v_exp_f32 v68, v68
    v_mul_f32 v69, 0x3e22f983, v69
    v_mul_f32 v70, v70, v12
    v_mul_f32 v71, v71, v12
    v_cvt_pk_bf16_f32 v68, v68, v68
    v_lshlrev_b32 v68, 16, v68
    v_mul_f32 v68, v68, v12
    v_mul_f32 v68, 0xbfb8aa3b, v68
    s_lshl_b32 s43, s40, 11
    s_add_u32 s43, s43, 12288
    v_lshl_add_u32 v4, v13, 5, s43
    ds_write_b128 v4, v[64:67]
    ds_write_b128 v4, v[68:71] offset:16
    v_lshl_add_u32 v4, v2, 9, s43
    s_mov_b32 s43, 0
    s_waitcnt lgkmcnt(0)
KLOOP_6:
    ds_read_b128 v[64:67], v4 offset:0
    ds_read_b128 v[68:71], v4 offset:16
    ds_read_b128 v[72:75], v4 offset:32
    ds_read_b128 v[76:79], v4 offset:48
    ds_read_b128 v[80:83], v4 offset:64
    ds_read_b128 v[84:87], v4 offset:80
    ds_read_b128 v[88:91], v4 offset:96
    ds_read_b128 v[92:95], v4 offset:112
    v_add_u32 v4, 128, v4
    s_add_u32 s43, s43, 16
    s_waitcnt lgkmcnt(7)
    v_mul_f32 v32, v64, v11
    v_mul_f32 v33, v65, v11
    v_exp_f32 v32, v32
    v_fract_f32 v33, v33
    v_sin_f32 v34, v33
    v_cos_f32 v33, v33
    v_mul_f32 v20, v64, v8
    v_mul_f32 v21, v65, v8
    v_exp_f32 v20, v20
    v_fract_f32 v21, v21
    v_sin_f32 v22, v21
    v_cos_f32 v21, v21
    v_mul_f32 v24, v64, v9
    v_mul_f32 v25, v65, v9
    v_exp_f32 v24, v24
    v_fract_f32 v25, v25
    v_sin_f32 v26, v25
    v_cos_f32 v25, v25
    v_mul_f32 v28, v64, v10
    v_mul_f32 v29, v65, v10
    v_exp_f32 v28, v28
    v_fract_f32 v29, v29
    v_sin_f32 v30, v29
    v_cos_f32 v29, v29
    v_mul_f32 v44, v66, v33
    v_fma_f32 v44, -v67, v34, v44
    v_mul_f32 v44, v44, v32
    v_mul_f32 v45, v66, v34
    v_fma_f32 v45, v67, v33, v45
    v_mul_f32 v45, -v45, v32
    v_mul_f32 v21, v20, v21
    v_mul_f32 v22, v20, v22
    v_mul_f32 v25, v24, v25
    v_mul_f32 v26, v24, v26
    v_mul_f32 v29, v28, v29
    v_mul_f32 v30, v28, v30
    v_mfma_f32_16x16x4_f32 v[48:51], v21, v44, v[48:51]
    v_mfma_f32_16x16x4_f32 v[48:51], v22, v45, v[48:51]
    v_mfma_f32_16x16x4_f32 v[52:55], v25, v44, v[52:55]
    v_mfma_f32_16x16x4_f32 v[52:55], v26, v45, v[52:55]
    v_mfma_f32_16x16x4_f32 v[56:59], v29, v44, v[56:59]
    v_mfma_f32_16x16x4_f32 v[56:59], v30, v45, v[56:59]
    s_waitcnt lgkmcnt(6)
    v_mul_f32 v32, v68, v11
    v_mul_f32 v33, v69, v11
    v_exp_f32 v32, v32
    v_fract_f32 v33, v33
    v_sin_f32 v34, v33
    v_cos_f32 v33, v33
    v_mul_f32 v20, v68, v8
    v_mul_f32 v21, v69, v8
    v_exp_f32 v20, v20
    v_fract_f32 v21, v21
    v_sin_f32 v22, v21
    v_cos_f32 v21, v21
    v_mul_f32 v24, v68, v9
    v_mul_f32 v25, v69, v9
    v_exp_f32 v24, v24
    v_fract_f32 v25, v25
    v_sin_f32 v26, v25
    v_cos_f32 v25, v25
    v_mul_f32 v28, v68, v10
    v_mul_f32 v29, v69, v10
    v_exp_f32 v28, v28
    v_fract_f32 v29, v29
    v_sin_f32 v30, v29
    v_cos_f32 v29, v29
    v_mul_f32 v44, v70, v33
    v_fma_f32 v44, -v71, v34, v44
    v_mul_f32 v44, v44, v32
    v_mul_f32 v45, v70, v34
    v_fma_f32 v45, v71, v33, v45
    v_mul_f32 v45, -v45, v32
    v_mul_f32 v21, v20, v21
    v_mul_f32 v22, v20, v22
    v_mul_f32 v25, v24, v25
    v_mul_f32 v26, v24, v26
    v_mul_f32 v29, v28, v29
    v_mul_f32 v30, v28, v30
    v_mfma_f32_16x16x4_f32 v[48:51], v21, v44, v[48:51]
    v_mfma_f32_16x16x4_f32 v[48:51], v22, v45, v[48:51]
    v_mfma_f32_16x16x4_f32 v[52:55], v25, v44, v[52:55]
    v_mfma_f32_16x16x4_f32 v[52:55], v26, v45, v[52:55]
    v_mfma_f32_16x16x4_f32 v[56:59], v29, v44, v[56:59]
    v_mfma_f32_16x16x4_f32 v[56:59], v30, v45, v[56:59]
    s_waitcnt lgkmcnt(5)
    v_mul_f32 v32, v72, v11
    v_mul_f32 v33, v73, v11
    v_exp_f32 v32, v32
    v_fract_f32 v33, v33
    v_sin_f32 v34, v33
    v_cos_f32 v33, v33
    v_mul_f32 v20, v72, v8
    v_mul_f32 v21, v73, v8
    v_exp_f32 v20, v20
    v_fract_f32 v21, v21
    v_sin_f32 v22, v21
    v_cos_f32 v21, v21
    v_mul_f32 v24, v72, v9
    v_mul_f32 v25, v73, v9
    v_exp_f32 v24, v24
    v_fract_f32 v25, v25
    v_sin_f32 v26, v25
    v_cos_f32 v25, v25
    v_mul_f32 v28, v72, v10
    v_mul_f32 v29, v73, v10
    v_exp_f32 v28, v28
    v_fract_f32 v29, v29
    v_sin_f32 v30, v29
    v_cos_f32 v29, v29
    v_mul_f32 v44, v74, v33
    v_fma_f32 v44, -v75, v34, v44
    v_mul_f32 v44, v44, v32
    v_mul_f32 v45, v74, v34
    v_fma_f32 v45, v75, v33, v45
    v_mul_f32 v45, -v45, v32
    v_mul_f32 v21, v20, v21
    v_mul_f32 v22, v20, v22
    v_mul_f32 v25, v24, v25
    v_mul_f32 v26, v24, v26
    v_mul_f32 v29, v28, v29
    v_mul_f32 v30, v28, v30
    v_mfma_f32_16x16x4_f32 v[48:51], v21, v44, v[48:51]
    v_mfma_f32_16x16x4_f32 v[48:51], v22, v45, v[48:51]
    v_mfma_f32_16x16x4_f32 v[52:55], v25, v44, v[52:55]
    v_mfma_f32_16x16x4_f32 v[52:55], v26, v45, v[52:55]
    v_mfma_f32_16x16x4_f32 v[56:59], v29, v44, v[56:59]
    v_mfma_f32_16x16x4_f32 v[56:59], v30, v45, v[56:59]
    s_waitcnt lgkmcnt(4)
    v_mul_f32 v32, v76, v11
    v_mul_f32 v33, v77, v11
    v_exp_f32 v32, v32
    v_fract_f32 v33, v33
    v_sin_f32 v34, v33
    v_cos_f32 v33, v33
    v_mul_f32 v20, v76, v8
    v_mul_f32 v21, v77, v8
    v_exp_f32 v20, v20
    v_fract_f32 v21, v21
    v_sin_f32 v22, v21
    v_cos_f32 v21, v21
    v_mul_f32 v24, v76, v9
    v_mul_f32 v25, v77, v9
    v_exp_f32 v24, v24
    v_fract_f32 v25, v25
    v_sin_f32 v26, v25
    v_cos_f32 v25, v25
    v_mul_f32 v28, v76, v10
    v_mul_f32 v29, v77, v10
    v_exp_f32 v28, v28
    v_fract_f32 v29, v29
    v_sin_f32 v30, v29
    v_cos_f32 v29, v29
    v_mul_f32 v44, v78, v33
    v_fma_f32 v44, -v79, v34, v44
    v_mul_f32 v44, v44, v32
    v_mul_f32 v45, v78, v34
    v_fma_f32 v45, v79, v33, v45
    v_mul_f32 v45, -v45, v32
    v_mul_f32 v21, v20, v21
    v_mul_f32 v22, v20, v22
    v_mul_f32 v25, v24, v25
    v_mul_f32 v26, v24, v26
    v_mul_f32 v29, v28, v29
    v_mul_f32 v30, v28, v30
    v_mfma_f32_16x16x4_f32 v[48:51], v21, v44, v[48:51]
    v_mfma_f32_16x16x4_f32 v[48:51], v22, v45, v[48:51]
    v_mfma_f32_16x16x4_f32 v[52:55], v25, v44, v[52:55]
    v_mfma_f32_16x16x4_f32 v[52:55], v26, v45, v[52:55]
    v_mfma_f32_16x16x4_f32 v[56:59], v29, v44, v[56:59]
    v_mfma_f32_16x16x4_f32 v[56:59], v30, v45, v[56:59]
    s_waitcnt lgkmcnt(3)
    v_mul_f32 v32, v80, v11
    v_mul_f32 v33, v81, v11
    v_exp_f32 v32, v32
    v_fract_f32 v33, v33
    v_sin_f32 v34, v33
    v_cos_f32 v33, v33
    v_mul_f32 v20, v80, v8
    v_mul_f32 v21, v81, v8
    v_exp_f32 v20, v20
    v_fract_f32 v21, v21
    v_sin_f32 v22, v21
    v_cos_f32 v21, v21
    v_mul_f32 v24, v80, v9
    v_mul_f32 v25, v81, v9
    v_exp_f32 v24, v24
    v_fract_f32 v25, v25
    v_sin_f32 v26, v25
    v_cos_f32 v25, v25
    v_mul_f32 v28, v80, v10
    v_mul_f32 v29, v81, v10
    v_exp_f32 v28, v28
    v_fract_f32 v29, v29
    v_sin_f32 v30, v29
    v_cos_f32 v29, v29
    v_mul_f32 v44, v82, v33
    v_fma_f32 v44, -v83, v34, v44
    v_mul_f32 v44, v44, v32
    v_mul_f32 v45, v82, v34
    v_fma_f32 v45, v83, v33, v45
    v_mul_f32 v45, -v45, v32
    v_mul_f32 v21, v20, v21
    v_mul_f32 v22, v20, v22
    v_mul_f32 v25, v24, v25
    v_mul_f32 v26, v24, v26
    v_mul_f32 v29, v28, v29
    v_mul_f32 v30, v28, v30
    v_mfma_f32_16x16x4_f32 v[48:51], v21, v44, v[48:51]
    v_mfma_f32_16x16x4_f32 v[48:51], v22, v45, v[48:51]
    v_mfma_f32_16x16x4_f32 v[52:55], v25, v44, v[52:55]
    v_mfma_f32_16x16x4_f32 v[52:55], v26, v45, v[52:55]
    v_mfma_f32_16x16x4_f32 v[56:59], v29, v44, v[56:59]
    v_mfma_f32_16x16x4_f32 v[56:59], v30, v45, v[56:59]
    s_waitcnt lgkmcnt(2)
    v_mul_f32 v32, v84, v11
    v_mul_f32 v33, v85, v11
    v_exp_f32 v32, v32
    v_fract_f32 v33, v33
    v_sin_f32 v34, v33
    v_cos_f32 v33, v33
    v_mul_f32 v20, v84, v8
    v_mul_f32 v21, v85, v8
    v_exp_f32 v20, v20
    v_fract_f32 v21, v21
    v_sin_f32 v22, v21
    v_cos_f32 v21, v21
    v_mul_f32 v24, v84, v9
    v_mul_f32 v25, v85, v9
    v_exp_f32 v24, v24
    v_fract_f32 v25, v25
    v_sin_f32 v26, v25
    v_cos_f32 v25, v25
    v_mul_f32 v28, v84, v10
    v_mul_f32 v29, v85, v10
    v_exp_f32 v28, v28
    v_fract_f32 v29, v29
    v_sin_f32 v30, v29
    v_cos_f32 v29, v29
    v_mul_f32 v44, v86, v33
    v_fma_f32 v44, -v87, v34, v44
    v_mul_f32 v44, v44, v32
    v_mul_f32 v45, v86, v34
    v_fma_f32 v45, v87, v33, v45
    v_mul_f32 v45, -v45, v32
    v_mul_f32 v21, v20, v21
    v_mul_f32 v22, v20, v22
    v_mul_f32 v25, v24, v25
    v_mul_f32 v26, v24, v26
    v_mul_f32 v29, v28, v29
    v_mul_f32 v30, v28, v30
    v_mfma_f32_16x16x4_f32 v[48:51], v21, v44, v[48:51]
    v_mfma_f32_16x16x4_f32 v[48:51], v22, v45, v[48:51]
    v_mfma_f32_16x16x4_f32 v[52:55], v25, v44, v[52:55]
    v_mfma_f32_16x16x4_f32 v[52:55], v26, v45, v[52:55]
    v_mfma_f32_16x16x4_f32 v[56:59], v29, v44, v[56:59]
    v_mfma_f32_16x16x4_f32 v[56:59], v30, v45, v[56:59]
    s_waitcnt lgkmcnt(1)
    v_mul_f32 v32, v88, v11
    v_mul_f32 v33, v89, v11
    v_exp_f32 v32, v32
    v_fract_f32 v33, v33
    v_sin_f32 v34, v33
    v_cos_f32 v33, v33
    v_mul_f32 v20, v88, v8
    v_mul_f32 v21, v89, v8
    v_exp_f32 v20, v20
    v_fract_f32 v21, v21
    v_sin_f32 v22, v21
    v_cos_f32 v21, v21
    v_mul_f32 v24, v88, v9
    v_mul_f32 v25, v89, v9
    v_exp_f32 v24, v24
    v_fract_f32 v25, v25
    v_sin_f32 v26, v25
    v_cos_f32 v25, v25
    v_mul_f32 v28, v88, v10
    v_mul_f32 v29, v89, v10
    v_exp_f32 v28, v28
    v_fract_f32 v29, v29
    v_sin_f32 v30, v29
    v_cos_f32 v29, v29
    v_mul_f32 v44, v90, v33
    v_fma_f32 v44, -v91, v34, v44
    v_mul_f32 v44, v44, v32
    v_mul_f32 v45, v90, v34
    v_fma_f32 v45, v91, v33, v45
    v_mul_f32 v45, -v45, v32
    v_mul_f32 v21, v20, v21
    v_mul_f32 v22, v20, v22
    v_mul_f32 v25, v24, v25
    v_mul_f32 v26, v24, v26
    v_mul_f32 v29, v28, v29
    v_mul_f32 v30, v28, v30
    v_mfma_f32_16x16x4_f32 v[48:51], v21, v44, v[48:51]
    v_mfma_f32_16x16x4_f32 v[48:51], v22, v45, v[48:51]
    v_mfma_f32_16x16x4_f32 v[52:55], v25, v44, v[52:55]
    v_mfma_f32_16x16x4_f32 v[52:55], v26, v45, v[52:55]
    v_mfma_f32_16x16x4_f32 v[56:59], v29, v44, v[56:59]
    v_mfma_f32_16x16x4_f32 v[56:59], v30, v45, v[56:59]
    s_waitcnt lgkmcnt(0)
    v_mul_f32 v32, v92, v11
    v_mul_f32 v33, v93, v11
    v_exp_f32 v32, v32
    v_fract_f32 v33, v33
    v_sin_f32 v34, v33
    v_cos_f32 v33, v33
    v_mul_f32 v20, v92, v8
    v_mul_f32 v21, v93, v8
    v_exp_f32 v20, v20
    v_fract_f32 v21, v21
    v_sin_f32 v22, v21
    v_cos_f32 v21, v21
    v_mul_f32 v24, v92, v9
    v_mul_f32 v25, v93, v9
    v_exp_f32 v24, v24
    v_fract_f32 v25, v25
    v_sin_f32 v26, v25
    v_cos_f32 v25, v25
    v_mul_f32 v28, v92, v10
    v_mul_f32 v29, v93, v10
    v_exp_f32 v28, v28
    v_fract_f32 v29, v29
    v_sin_f32 v30, v29
    v_cos_f32 v29, v29
    v_mul_f32 v44, v94, v33
    v_fma_f32 v44, -v95, v34, v44
    v_mul_f32 v44, v44, v32
    v_mul_f32 v45, v94, v34
    v_fma_f32 v45, v95, v33, v45
    v_mul_f32 v45, -v45, v32
    v_mul_f32 v21, v20, v21
    v_mul_f32 v22, v20, v22
    v_mul_f32 v25, v24, v25
    v_mul_f32 v26, v24, v26
    v_mul_f32 v29, v28, v29
    v_mul_f32 v30, v28, v30
    v_mfma_f32_16x16x4_f32 v[48:51], v21, v44, v[48:51]
    v_mfma_f32_16x16x4_f32 v[48:51], v22, v45, v[48:51]
    v_mfma_f32_16x16x4_f32 v[52:55], v25, v44, v[52:55]
    v_mfma_f32_16x16x4_f32 v[52:55], v26, v45, v[52:55]
    v_mfma_f32_16x16x4_f32 v[56:59], v29, v44, v[56:59]
    v_mfma_f32_16x16x4_f32 v[56:59], v30, v45, v[56:59]
    s_cmp_lt_u32 s43, 64
    s_nop 8
    s_cbranch_scc1 KLOOP_6
    s_mul_i32 s42, s40, 3072
    v_lshlrev_b32 v5, 8, v2
    v_lshl_add_u32 v5, v1, 2, v5
    v_add_u32 v5, s42, v5
    v_mul_f32 v48, 2.0, v48
    ds_write_b32 v5, v48 offset:0
    v_mul_f32 v49, 2.0, v49
    ds_write_b32 v5, v49 offset:64
    v_mul_f32 v50, 2.0, v50
    ds_write_b32 v5, v50 offset:128
    v_mul_f32 v51, 2.0, v51
    ds_write_b32 v5, v51 offset:192
    v_mul_f32 v52, 2.0, v52
    ds_write_b32 v5, v52 offset:1024
    v_mul_f32 v53, 2.0, v53
    ds_write_b32 v5, v53 offset:1088
    v_mul_f32 v54, 2.0, v54
    ds_write_b32 v5, v54 offset:1152
    v_mul_f32 v55, 2.0, v55
    ds_write_b32 v5, v55 offset:1216
    v_mul_f32 v56, 2.0, v56
    ds_write_b32 v5, v56 offset:2048
    v_mul_f32 v57, 2.0, v57
    ds_write_b32 v5, v57 offset:2112
    v_mul_f32 v58, 2.0, v58
    ds_write_b32 v5, v58 offset:2176
    v_mul_f32 v59, 2.0, v59
    ds_write_b32 v5, v59 offset:2240
    v_and_b32 v13, 63, v0
    v_lshlrev_b32 v5, 3, v13
    v_sub_u32 v5, 2047, v5
    s_add_u32 s4, s30, 0x1100000
    s_addc_u32 s5, s31, 0
    s_mov_b32 s6, 0x252000
    s_mov_b32 s7, 0x00020000
    s_mul_i32 s34, s41, 4224
    s_add_u32 s44, s34, 4096
    v_lshlrev_b32 v14, 4, v13
    s_waitcnt vmcnt(0) lgkmcnt(0)
    s_nop 0
KEXP_7:
    v_subrev_u32 v20, 0, v5
    v_cvt_f32_u32 v20, v20
    v_cvt_pk_bf16_f32 v20, v20, v20
    v_lshlrev_b32 v20, 16, v20
    v_cvt_u32_f32 v20, v20
    v_or_b32 v23, 1, v20
    v_ffbh_u32 v23, v23
    v_sub_u32 v23, 24, v23
    v_med3_i32 v23, v23, 0, 3
    v_lshrrev_b32 v21, 7, v20
    v_and_b32 v22, 7, v20
    v_lshrrev_b32 v22, v23, v22
    v_sub_u32 v24, 3, v23
    v_lshlrev_b32 v21, v24, v21
    v_lshl_add_u32 v21, v23, 3, v21
    v_add_u32 v21, v21, v22
    v_bfe_u32 v22, v20, 3, 4
    v_lshl_add_u32 v21, v21, 4, v22
    v_lshl_add_u32 v21, v21, 2, s42
    ds_read_b32 v64, v21
    v_subrev_u32 v20, 1, v5
    v_cvt_f32_u32 v20, v20
    v_cvt_pk_bf16_f32 v20, v20, v20
    v_lshlrev_b32 v20, 16, v20
    v_cvt_u32_f32 v20, v20
    v_or_b32 v23, 1, v20
    v_ffbh_u32 v23, v23
    v_sub_u32 v23, 24, v23
    v_med3_i32 v23, v23, 0, 3
    v_lshrrev_b32 v21, 7, v20
    v_and_b32 v22, 7, v20
    v_lshrrev_b32 v22, v23, v22
    v_sub_u32 v24, 3, v23
    v_lshlrev_b32 v21, v24, v21
    v_lshl_add_u32 v21, v23, 3, v21
    v_add_u32 v21, v21, v22
    v_bfe_u32 v22, v20, 3, 4
    v_lshl_add_u32 v21, v21, 4, v22
    v_lshl_add_u32 v21, v21, 2, s42
    ds_read_b32 v65, v21
    v_subrev_u32 v20, 2, v5
    v_cvt_f32_u32 v20, v20
    v_cvt_pk_bf16_f32 v20, v20, v20
    v_lshlrev_b32 v20, 16, v20
    v_cvt_u32_f32 v20, v20
    v_or_b32 v23, 1, v20
    v_ffbh_u32 v23, v23
    v_sub_u32 v23, 24, v23
    v_med3_i32 v23, v23, 0, 3
    v_lshrrev_b32 v21, 7, v20
    v_and_b32 v22, 7, v20
    v_lshrrev_b32 v22, v23, v22
    v_sub_u32 v24, 3, v23
    v_lshlrev_b32 v21, v24, v21
    v_lshl_add_u32 v21, v23, 3, v21
    v_add_u32 v21, v21, v22
    v_bfe_u32 v22, v20, 3, 4
    v_lshl_add_u32 v21, v21, 4, v22
    v_lshl_add_u32 v21, v21, 2, s42
    ds_read_b32 v66, v21
    v_subrev_u32 v20, 3, v5
    v_cvt_f32_u32 v20, v20
    v_cvt_pk_bf16_f32 v20, v20, v20
    v_lshlrev_b32 v20, 16, v20
    v_cvt_u32_f32 v20, v20
    v_or_b32 v23, 1, v20
    v_ffbh_u32 v23, v23
    v_sub_u32 v23, 24, v23
    v_med3_i32 v23, v23, 0, 3
    v_lshrrev_b32 v21, 7, v20
    v_and_b32 v22, 7, v20
    v_lshrrev_b32 v22, v23, v22
    v_sub_u32 v24, 3, v23
    v_lshlrev_b32 v21, v24, v21
    v_lshl_add_u32 v21, v23, 3, v21
    v_add_u32 v21, v21, v22
    v_bfe_u32 v22, v20, 3, 4
    v_lshl_add_u32 v21, v21, 4, v22
    v_lshl_add_u32 v21, v21, 2, s42
    ds_read_b32 v67, v21
    v_subrev_u32 v20, 4, v5
    v_cvt_f32_u32 v20, v20
    v_cvt_pk_bf16_f32 v20, v20, v20
    v_lshlrev_b32 v20, 16, v20
    v_cvt_u32_f32 v20, v20
    v_or_b32 v23, 1, v20
    v_ffbh_u32 v23, v23
    v_sub_u32 v23, 24, v23
    v_med3_i32 v23, v23, 0, 3
    v_lshrrev_b32 v21, 7, v20
    v_and_b32 v22, 7, v20
    v_lshrrev_b32 v22, v23, v22
    v_sub_u32 v24, 3, v23
    v_lshlrev_b32 v21, v24, v21
    v_lshl_add_u32 v21, v23, 3, v21
    v_add_u32 v21, v21, v22
    v_bfe_u32 v22, v20, 3, 4
    v_lshl_add_u32 v21, v21, 4, v22
    v_lshl_add_u32 v21, v21, 2, s42
    ds_read_b32 v68, v21
    v_subrev_u32 v20, 5, v5
    v_cvt_f32_u32 v20, v20
    v_cvt_pk_bf16_f32 v20, v20, v20
    v_lshlrev_b32 v20, 16, v20
    v_cvt_u32_f32 v20, v20
    v_or_b32 v23, 1, v20
    v_ffbh_u32 v23, v23
    v_sub_u32 v23, 24, v23
    v_med3_i32 v23, v23, 0, 3
    v_lshrrev_b32 v21, 7, v20
    v_and_b32 v22, 7, v20
    v_lshrrev_b32 v22, v23, v22
    v_sub_u32 v24, 3, v23
    v_lshlrev_b32 v21, v24, v21
    v_lshl_add_u32 v21, v23, 3, v21
    v_add_u32 v21, v21, v22
    v_bfe_u32 v22, v20, 3, 4
    v_lshl_add_u32 v21, v21, 4, v22
    v_lshl_add_u32 v21, v21, 2, s42
    ds_read_b32 v69, v21
    v_subrev_u32 v20, 6, v5
    v_cvt_f32_u32 v20, v20
    v_cvt_pk_bf16_f32 v20, v20, v20
    v_lshlrev_b32 v20, 16, v20
    v_cvt_u32_f32 v20, v20
    v_or_b32 v23, 1, v20
    v_ffbh_u32 v23, v23
    v_sub_u32 v23, 24, v23
    v_med3_i32 v23, v23, 0, 3
    v_lshrrev_b32 v21, 7, v20
    v_and_b32 v22, 7, v20
    v_lshrrev_b32 v22, v23, v22
    v_sub_u32 v24, 3, v23
    v_lshlrev_b32 v21, v24, v21
    v_lshl_add_u32 v21, v23, 3, v21
    v_add_u32 v21, v21, v22
    v_bfe_u32 v22, v20, 3, 4
    v_lshl_add_u32 v21, v21, 4, v22
    v_lshl_add_u32 v21, v21, 2, s42
    ds_read_b32 v70, v21
    v_subrev_u32 v20, 7, v5
    v_cvt_f32_u32 v20, v20
    v_cvt_pk_bf16_f32 v20, v20, v20
    v_lshlrev_b32 v20, 16, v20
    v_cvt_u32_f32 v20, v20
    v_or_b32 v23, 1, v20
    v_ffbh_u32 v23, v23
    v_sub_u32 v23, 24, v23
    v_med3_i32 v23, v23, 0, 3
    v_lshrrev_b32 v21, 7, v20
    v_and_b32 v22, 7, v20
    v_lshrrev_b32 v22, v23, v22
    v_sub_u32 v24, 3, v23
    v_lshlrev_b32 v21, v24, v21
    v_lshl_add_u32 v21, v23, 3, v21
    v_add_u32 v21, v21, v22
    v_bfe_u32 v22, v20, 3, 4
    v_lshl_add_u32 v21, v21, 4, v22
    v_lshl_add_u32 v21, v21, 2, s42
    ds_read_b32 v71, v21
    v_subrev_u32 v5, 512, v5
    s_waitcnt lgkmcnt(0)
    v_cvt_pk_bf16_f32 v72, v64, v65
    v_cvt_pk_bf16_f32 v73, v66, v67
    v_cvt_pk_bf16_f32 v74, v68, v69
    v_cvt_pk_bf16_f32 v75, v70, v71
    buffer_store_dwordx4 v[72:75], v14, s[4:7], s34 offen
    s_add_u32 s34, s34, 1024
    s_cmp_lt_u32 s34, s44
    s_cbranch_scc1 KEXP_7
    v_mov_b32 v40, 0
    v_mov_b32 v41, 0
    v_mov_b32 v42, 0
    v_mov_b32 v43, 0
    v_cmp_gt_u32 vcc, 8, v13
    s_and_saveexec_b64 s[38:39], vcc
    buffer_store_dwordx4 v[40:43], v14, s[4:7], s34 offen
    s_mov_b64 exec, s[38:39]
    s_waitcnt vmcnt(0)
END_1:
    s_endpgm
.globl l2_kernel
.p2align 8
.type l2_kernel,@function
l2_kernel:
    s_cmp_ge_u32 s2, 256
    s_cbranch_scc1 CONV_9
    s_load_dwordx2 s[24:25], s[0:1], 104
    s_waitcnt lgkmcnt(0)
    s_mov_b32 s4, s24
    s_mov_b32 s5, s25
    s_mov_b32 s6, 0x6c0000
    s_mov_b32 s7, 0x00020000
    s_add_u32 s8, s24, 0x800000
    s_addc_u32 s9, s25, 0
    s_mov_b32 s10, 0x240000
    s_mov_b32 s11, 0x00020000
    s_and_b32 s26, s2, 7
    s_lshr_b32 s27, s2, 3
    s_and_b32 s27, s27, 3
    s_lshl_b32 s27, s27, 3
    s_add_u32 s26, s26, s27
    s_lshr_b32 s27, s2, 5
    s_lshl_b32 s27, s27, 8
    s_mul_i32 s30, s26, 18
    s_add_u32 s30, s30, 576
    v_lshrrev_b32 v10, 6, v0
    v_and_b32 v11, 1, v10
    v_lshrrev_b32 v12, 1, v10
    v_bfe_u32 v13, v0, 4, 2
    v_mad_u32_u24 v13, v11, 9, v13
    v_and_b32 v14, 15, v0
    v_lshlrev_b32 v14, 4, v14
    v_mul_u32_u24 v15, 48, v12
    v_sub_u32 v15, 320, v15
    v_mul_u32_u24 v10, 6400, v12
    v_add_u32 v10, v10, v14
    v_mul_u32_u24 v12, 576, v12
    v_add_u32 v12, s30, v12
    v_add_u32 v11, 0, v13
    v_mul_u32_u24 v7, v11, v15
    v_add_u32 v7, v7, v10
    v_add_u32 v4, v11, v12
    v_lshlrev_b32 v4, 12, v4
    v_add_u32 v4, v4, v14
    v_add_u32 v11, 4, v13
    v_mul_u32_u24 v8, v11, v15
    v_add_u32 v8, v8, v10
    v_add_u32 v5, v11, v12
    v_lshlrev_b32 v5, 12, v5
    v_add_u32 v5, v5, v14
    v_add_u32 v11, 8, v13
    v_mul_u32_u24 v9, v11, v15
    v_add_u32 v9, v9, v10
    v_add_u32 v6, v11, v12
    v_lshlrev_b32 v6, 12, v6
    v_add_u32 v6, v6, v14
    v_bfe_u32 v10, v0, 5, 1
    v_bfe_u32 v11, v0, 2, 2
    v_bfe_u32 v12, v0, 4, 1
    v_and_b32 v13, 3, v0
    v_lshlrev_b32 v13, 3, v13
    v_lshl_add_u32 v13, v12, 5, v13
    v_lshl_add_u32 v14, v10, 3, v11
    v_mul_u32_u24 v1, 320, v14
    v_add_u32 v1, v1, v13
    v_add_u32 v14, 16, v11
    v_mul_u32_u24 v2, 320, v14
    v_add_u32 v2, v2, v13
    v_and_b32 v14, 31, v0
    v_min_u32 v14, 19, v14
    v_mul_u32_u24 v3, 272, v14
    v_lshl_add_u32 v3, v10, 4, v3
    v_add_u32 v3, 6400, v3
    v_cmp_eq_u32 vcc, 0, v10
    s_mov_b64 s[32:33], vcc
    v_and_b32 v11, 63, v0
    v_cmp_gt_u32 vcc, 16, v11
    s_mov_b64 s[34:35], vcc
    s_mov_b32 s36, 0
    s_mov_b32 s28, 0
    buffer_load_dwordx4 v[20:23], v4, s[4:7], s28 offen
    buffer_load_dwordx4 v[24:27], v5, s[4:7], s28 offen
    s_mov_b64 exec, s[34:35]
    buffer_load_dwordx4 v[28:31], v6, s[4:7], s28 offen
    s_mov_b64 exec, -1
    s_add_u32 s28, s28, 256
    v_lshrrev_b32 v11, 6, v0
    v_lshlrev_b32 v11, 6, v11
    v_and_b32 v12, 31, v0
    v_add3_u32 v11, v11, v12, s27
    v_mul_u32_u24 v16, 1152, v11
    v_lshlrev_b32 v11, 1, v11
    v_lshl_add_u32 v12, v10, 15, v11
    s_sub_u32 s29, s30, 576
    s_lshl_b32 s29, s29, 12
    s_add_u32 s31, s29, 0
    buffer_load_ushort v96, v12, s[4:7], s31 offen
    s_add_u32 s31, s29, 4096
    buffer_load_ushort v97, v12, s[4:7], s31 offen
    s_add_u32 s31, s29, 8192
    buffer_load_ushort v98, v12, s[4:7], s31 offen
    s_add_u32 s31, s29, 12288
    buffer_load_ushort v99, v12, s[4:7], s31 offen
    s_add_u32 s31, s29, 16384
    buffer_load_ushort v100, v12, s[4:7], s31 offen
    s_add_u32 s31, s29, 20480
    buffer_load_ushort v101, v12, s[4:7], s31 offen
    s_add_u32 s31, s29, 24576
    buffer_load_ushort v102, v12, s[4:7], s31 offen
    s_add_u32 s31, s29, 28672
    buffer_load_ushort v103, v12, s[4:7], s31 offen
    s_add_u32 s31, s29, 65536
    buffer_load_ushort v104, v11, s[4:7], s31 offen
    s_add_u32 s31, s29, 69632
    buffer_load_ushort v105, v11, s[4:7], s31 offen
    v_mov_b32 v41, 0
    v_mov_b32 v42, 0
    v_mov_b32 v43, 0
    s_add_u32 s31, s29, 64
    buffer_load_ushort v128, v12, s[4:7], s31 offen
    s_add_u32 s31, s29, 4160
    buffer_load_ushort v129, v12, s[4:7], s31 offen
    s_add_u32 s31, s29, 8256
    buffer_load_ushort v130, v12, s[4:7], s31 offen
    s_add_u32 s31, s29, 12352
    buffer_load_ushort v131, v12, s[4:7], s31 offen
    s_add_u32 s31, s29, 16448
    buffer_load_ushort v132, v12, s[4:7], s31 offen
    s_add_u32 s31, s29, 20544
    buffer_load_ushort v133, v12, s[4:7], s31 offen
    s_add_u32 s31, s29, 24640
    buffer_load_ushort v134, v12, s[4:7], s31 offen
    s_add_u32 s31, s29, 28736
    buffer_load_ushort v135, v12, s[4:7], s31 offen
    s_add_u32 s31, s29, 65600
    buffer_load_ushort v136, v11, s[4:7], s31 offen
    s_add_u32 s31, s29, 69696
    buffer_load_ushort v137, v11, s[4:7], s31 offen
    v_mov_b32 v45, 0
    v_mov_b32 v46, 0
    v_mov_b32 v47, 0
    v_mov_b32 v58, 0
    v_mov_b32 v59, 0
    v_mov_b32 v62, 0
    v_mov_b32 v63, 0
    v_bfe_u32 v13, v0, 4, 2
    v_lshrrev_b32 v14, 1, v13
    v_and_b32 v13, 1, v13
    v_add_u32 v15, 18, v13
    v_mul_u32_u24 v12, 320, v15
    v_mul_u32_u24 v15, 272, v15
    v_add_u32 v15, 6400, v15
    v_cmp_eq_u32 vcc, 1, v14
    s_nop 1
    v_cndmask_b32 v12, v12, v15, vcc
    v_and_b32 v15, 15, v0
    v_lshl_add_u32 v12, v15, 4, v12
    v_lshrrev_b32 v15, 6, v0
    v_mul_u32_u24 v15, 11840, v15
    v_add_u32 v12, v12, v15
    v_and_b32 v13, v13, v14
    v_cmp_eq_u32 vcc, 0, v13
    v_mov_b32 v13, 0x3f803f80
    s_nop 0
    v_cndmask_b32 v13, 0, v13, vcc
    v_mov_b32 v80, v13
    v_mov_b32 v81, v13
    v_mov_b32 v82, v13
    v_mov_b32 v83, v13
    ds_write_b128 v12, v[80:83]
    s_waitcnt vmcnt(0)
    ds_write_b128 v7, v[20:23] offset:0
    ds_write_b128 v8, v[24:27] offset:0
    s_mov_b64 exec, s[34:35]
    ds_write_b128 v9, v[28:31] offset:0
    s_mov_b64 exec, -1
    buffer_load_dwordx4 v[20:23], v4, s[4:7], s28 offen
    buffer_load_dwordx4 v[24:27], v5, s[4:7], s28 offen
    s_mov_b64 exec, s[34:35]
    buffer_load_dwordx4 v[28:31], v6, s[4:7], s28 offen
    s_mov_b64 exec, -1
    s_add_u32 s28, s28, 256
    v_lshl_or_b32 v32, v97, 16, v96
    v_lshl_or_b32 v33, v99, 16, v98
    v_lshl_or_b32 v34, v101, 16, v100
    v_lshl_or_b32 v35, v103, 16, v102
    v_lshl_or_b32 v40, v105, 16, v104
    v_cndmask_b32 v40, 0, v40, s[32:33]
    v_lshl_or_b32 v36, v129, 16, v128
    v_lshl_or_b32 v37, v131, 16, v130
    v_lshl_or_b32 v38, v133, 16, v132
    v_lshl_or_b32 v39, v135, 16, v134
    v_lshl_or_b32 v44, v137, 16, v136
    v_cndmask_b32 v44, 0, v44, s[32:33]
    s_nop 1
    s_branch AP1_10
APASS2_11:
    s_mov_b32 s28, 0
    buffer_load_dwordx4 v[20:23], v4, s[4:7], s28 offen
    buffer_load_dwordx4 v[24:27], v5, s[4:7], s28 offen
    s_mov_b64 exec, s[34:35]
    buffer_load_dwordx4 v[28:31], v6, s[4:7], s28 offen
    s_mov_b64 exec, -1
    s_add_u32 s28, s28, 256
    s_waitcnt vmcnt(0)
    ds_write_b128 v7, v[20:23] offset:0
    ds_write_b128 v8, v[24:27] offset:0
    s_mov_b64 exec, s[34:35]
    ds_write_b128 v9, v[28:31] offset:0
    s_mov_b64 exec, -1
    buffer_load_dwordx4 v[20:23], v4, s[4:7], s28 offen
    buffer_load_dwordx4 v[24:27], v5, s[4:7], s28 offen
    s_mov_b64 exec, s[34:35]
    buffer_load_dwordx4 v[28:31], v6, s[4:7], s28 offen
    s_mov_b64 exec, -1
    s_add_u32 s28, s28, 256
AP1_10:
    s_waitcnt lgkmcnt(0)
    s_barrier
    ds_read_b64_tr_b16 v[48:49], v1 offset:0
    ds_read_b64_tr_b16 v[50:51], v1 offset:1280
    ds_read_b64_tr_b16 v[56:57], v2 offset:0
    ds_read_b64_tr_b16 v[52:53], v1 offset:64
    ds_read_b64_tr_b16 v[54:55], v1 offset:1344
    ds_read_b64_tr_b16 v[60:61], v2 offset:64
    s_waitcnt lgkmcnt(3)
    s_cmp_lg_u32 s36, 0
    s_cbranch_scc1 ASKIPM_14
    v_mfma_f32_32x32x16_bf16 v[80:95], v[48:51], v[32:35], 0
    v_mfma_f32_32x32x16_bf16 v[80:95], v[56:59], v[40:43], v[80:95]
    v_mfma_f32_32x32x16_bf16 v[112:127], v[48:51], v[36:39], 0
    v_mfma_f32_32x32x16_bf16 v[112:127], v[56:59], v[44:47], v[112:127]
    s_nop 9
    v_max3_f32 v10, v80, v81, v82
    v_max3_f32 v10, v10, v83, v84
    v_max3_f32 v10, v10, v85, v86
    v_max3_f32 v10, v10, v87, v88
    v_max3_f32 v10, v10, v89, v90
    v_max3_f32 v10, v10, v91, v92
    v_max3_f32 v10, v10, v93, v94
    v_max_f32 v10, v10, v95
    v_mov_b32 v11, v10
    s_nop 1
    v_permlane32_swap_b32 v10, v11
    v_max_f32 v10, v10, v11
    v_cvt_pk_bf16_f32 v11, v10, v10
    v_lshlrev_b32 v11, 16, v11
    v_sub_f32 v12, v10, v11
    v_cvt_pk_bf16_f32 v12, -v11, -v12
    v_cndmask_b32 v41, 0, v12, s[32:33]
    v_max3_f32 v10, v112, v113, v114
    v_max3_f32 v10, v10, v115, v116
    v_max3_f32 v10, v10, v117, v118
    v_max3_f32 v10, v10, v119, v120
    v_max3_f32 v10, v10, v121, v122
    v_max3_f32 v10, v10, v123, v124
    v_max3_f32 v10, v10, v125, v126
    v_max_f32 v10, v10, v127
    v_mov_b32 v11, v10
    s_nop 1
    v_permlane32_swap_b32 v10, v11
    v_max_f32 v10, v10, v11
    v_cvt_pk_bf16_f32 v11, v10, v10
    v_lshlrev_b32 v11, 16, v11
    v_sub_f32 v12, v10, v11
    v_cvt_pk_bf16_f32 v12, -v11, -v12
    v_cndmask_b32 v45, 0, v12, s[32:33]
    s_nop 1
ASKIPM_14:
    v_mfma_f32_32x32x16_bf16 v[80:95], v[48:51], v[32:35], 0
    v_mfma_f32_32x32x16_bf16 v[80:95], v[56:59], v[40:43], v[80:95]
    v_mfma_f32_32x32x16_bf16 v[112:127], v[48:51], v[36:39], 0
    v_mfma_f32_32x32x16_bf16 v[112:127], v[56:59], v[44:47], v[112:127]
    v_mov_b32 v160, 0
    v_mov_b32 v161, 0
    v_mov_b32 v162, 0
    v_mov_b32 v163, 0
    v_mov_b32 v164, 0
    v_mov_b32 v165, 0
    v_mov_b32 v166, 0
    v_mov_b32 v167, 0
    v_mov_b32 v168, 0
    v_mov_b32 v169, 0
    v_mov_b32 v170, 0
    v_mov_b32 v171, 0
    v_mov_b32 v172, 0
    v_mov_b32 v173, 0
    v_mov_b32 v174, 0
    v_mov_b32 v175, 0
    v_mov_b32 v176, 0
    v_mov_b32 v177, 0
    v_mov_b32 v178, 0
    v_mov_b32 v179, 0
    v_mov_b32 v180, 0
    v_mov_b32 v181, 0
    v_mov_b32 v182, 0
    v_mov_b32 v183, 0
    v_mov_b32 v184, 0
    v_mov_b32 v185, 0
    v_mov_b32 v186, 0
    v_mov_b32 v187, 0
    v_mov_b32 v188, 0
    v_mov_b32 v189, 0
    v_mov_b32 v190, 0
    v_mov_b32 v191, 0
    v_mov_b32 v152, 0
    v_mov_b32 v153, 0
    v_mov_b32 v154, 0
    v_mov_b32 v155, 0
    v_mov_b32 v156, 0
    v_mov_b32 v157, 0
    v_mov_b32 v158, 0
    v_mov_b32 v159, 0
    v_mov_b32 v72, 0
    v_mov_b32 v73, 0
    v_mov_b32 v74, 0
    v_mov_b32 v75, 0
    v_mov_b32 v76, 0
    v_mov_b32 v77, 0
    v_mov_b32 v78, 0
    v_mov_b32 v79, 0
    s_mov_b32 s29, 0
    s_nop 0
ALOOP_15:
    s_waitcnt vmcnt(0)
    ds_write_b128 v7, v[20:23] offset:11840
    ds_write_b128 v8, v[24:27] offset:11840
    s_mov_b64 exec, s[34:35]
    ds_write_b128 v9, v[28:31] offset:11840
    s_mov_b64 exec, -1
    buffer_load_dwordx4 v[20:23], v4, s[4:7], s28 offen
    buffer_load_dwordx4 v[24:27], v5, s[4:7], s28 offen
    s_mov_b64 exec, s[34:35]
    buffer_load_dwordx4 v[28:31], v6, s[4:7], s28 offen
    s_mov_b64 exec, -1
    s_add_u32 s28, s28, 256
    ds_read_b128 v[64:67], v3 offset:0
    ds_read_b128 v[68:71], v3 offset:32
    v_mfma_f32_32x32x16_bf16 v[176:191], v[72:75], v[152:155], v[176:191]
    v_exp_f32 v80, v80
    v_exp_f32 v81, v81
    v_exp_f32 v82, v82
    v_exp_f32 v83, v83
    v_cvt_pk_bf16_f32 v144, v80, v81
    v_mfma_f32_32x32x16_bf16 v[176:191], v[76:79], v[156:159], v[176:191]
    v_exp_f32 v84, v84
    v_cvt_pk_bf16_f32 v145, v82, v83
    v_exp_f32 v85, v85
    v_exp_f32 v86, v86
    v_exp_f32 v87, v87
    v_cvt_pk_bf16_f32 v146, v84, v85
    v_cvt_pk_bf16_f32 v147, v86, v87
    s_waitcnt lgkmcnt(5)
    v_mfma_f32_32x32x16_bf16 v[96:111], v[52:55], v[32:35], 0
    v_exp_f32 v88, v88
    v_exp_f32 v89, v89
    v_exp_f32 v90, v90
    v_exp_f32 v91, v91
    v_cvt_pk_bf16_f32 v148, v88, v89
    v_mfma_f32_32x32x16_bf16 v[96:111], v[60:63], v[40:43], v[96:111]
    v_exp_f32 v92, v92
    v_cvt_pk_bf16_f32 v149, v90, v91
    v_exp_f32 v93, v93
    v_exp_f32 v94, v94
    v_exp_f32 v95, v95
    v_cvt_pk_bf16_f32 v150, v92, v93
    v_cvt_pk_bf16_f32 v151, v94, v95
    ds_read_b64_tr_b16 v[48:49], v1 offset:128
    ds_read_b64_tr_b16 v[50:51], v1 offset:1408
    ds_read_b64_tr_b16 v[56:57], v2 offset:128
    s_waitcnt lgkmcnt(3)
    v_mfma_f32_32x32x16_bf16 v[160:175], v[64:67], v[144:147], v[160:175]
    v_exp_f32 v112, v112
    v_exp_f32 v113, v113
    v_exp_f32 v114, v114
    v_exp_f32 v115, v115
    v_cvt_pk_bf16_f32 v152, v112, v113
    v_mfma_f32_32x32x16_bf16 v[160:175], v[68:71], v[148:151], v[160:175]
    v_exp_f32 v116, v116
    v_cvt_pk_bf16_f32 v153, v114, v115
    v_exp_f32 v117, v117
    v_exp_f32 v118, v118
    v_exp_f32 v119, v119
    v_cvt_pk_bf16_f32 v154, v116, v117
    v_cvt_pk_bf16_f32 v155, v118, v119
    v_mfma_f32_32x32x16_bf16 v[128:143], v[52:55], v[36:39], 0
    v_exp_f32 v120, v120
    v_exp_f32 v121, v121
    v_exp_f32 v122, v122
    v_exp_f32 v123, v123
    v_cvt_pk_bf16_f32 v156, v120, v121
    v_mfma_f32_32x32x16_bf16 v[128:143], v[60:63], v[44:47], v[128:143]
    v_exp_f32 v124, v124
    v_cvt_pk_bf16_f32 v157, v122, v123
    v_exp_f32 v125, v125
    v_exp_f32 v126, v126
    v_exp_f32 v127, v127
    v_cvt_pk_bf16_f32 v158, v124, v125
    v_cvt_pk_bf16_f32 v159, v126, v127
    ds_read_b128 v[72:75], v3 offset:64
    ds_read_b128 v[76:79], v3 offset:96
    v_mfma_f32_32x32x16_bf16 v[176:191], v[64:67], v[152:155], v[176:191]
    v_exp_f32 v96, v96
    v_exp_f32 v97, v97
    v_exp_f32 v98, v98
    v_exp_f32 v99, v99
    v_cvt_pk_bf16_f32 v144, v96, v97
    v_mfma_f32_32x32x16_bf16 v[176:191], v[68:71], v[156:159], v[176:191]
    v_exp_f32 v100, v100
    v_cvt_pk_bf16_f32 v145, v98, v99
    v_exp_f32 v101, v101
    v_exp_f32 v102, v102
    v_exp_f32 v103, v103
    v_cvt_pk_bf16_f32 v146, v100, v101
    v_cvt_pk_bf16_f32 v147, v102, v103
    s_waitcnt lgkmcnt(2)
    v_mfma_f32_32x32x16_bf16 v[80:95], v[48:51], v[32:35], 0
    v_exp_f32 v104, v104
    v_exp_f32 v105, v105
    v_exp_f32 v106, v106
    v_exp_f32 v107, v107
    v_cvt_pk_bf16_f32 v148, v104, v105
    v_mfma_f32_32x32x16_bf16 v[80:95], v[56:59], v[40:43], v[80:95]
    v_exp_f32 v108, v108
    v_cvt_pk_bf16_f32 v149, v106, v107
    v_exp_f32 v109, v109
    v_exp_f32 v110, v110
    v_exp_f32 v111, v111
    v_cvt_pk_bf16_f32 v150, v108, v109
    v_cvt_pk_bf16_f32 v151, v110, v111
    ds_read_b64_tr_b16 v[52:53], v1 offset:192
    ds_read_b64_tr_b16 v[54:55], v1 offset:1472
    ds_read_b64_tr_b16 v[60:61], v2 offset:192
    s_waitcnt lgkmcnt(3)
    v_mfma_f32_32x32x16_bf16 v[160:175], v[72:75], v[144:147], v[160:175]
    v_exp_f32 v128, v128
    v_exp_f32 v129, v129
    v_exp_f32 v130, v130
    v_exp_f32 v131, v131
    v_cvt_pk_bf16_f32 v152, v128, v129
    v_mfma_f32_32x32x16_bf16 v[160:175], v[76:79], v[148:151], v[160:175]
    v_exp_f32 v132, v132
    v_cvt_pk_bf16_f32 v153, v130, v131
    v_exp_f32 v133, v133
    v_exp_f32 v134, v134
    v_exp_f32 v135, v135
    v_cvt_pk_bf16_f32 v154, v132, v133
    v_cvt_pk_bf16_f32 v155, v134, v135
    v_mfma_f32_32x32x16_bf16 v[112:127], v[48:51], v[36:39], 0
    v_exp_f32 v136, v136
    v_exp_f32 v137, v137
    v_exp_f32 v138, v138
    v_exp_f32 v139, v139
    v_cvt_pk_bf16_f32 v156, v136, v137
    v_mfma_f32_32x32x16_bf16 v[112:127], v[56:59], v[44:47], v[112:127]
    v_exp_f32 v140, v140
    v_cvt_pk_bf16_f32 v157, v138, v139
    v_exp_f32 v141, v141
    v_exp_f32 v142, v142
    v_exp_f32 v143, v143
    v_cvt_pk_bf16_f32 v158, v140, v141
    v_cvt_pk_bf16_f32 v159, v142, v143
    s_barrier
    ds_read_b128 v[64:67], v3 offset:128
    ds_read_b128 v[68:71], v3 offset:160
    v_mfma_f32_32x32x16_bf16 v[176:191], v[72:75], v[152:155], v[176:191]
    v_exp_f32 v80, v80
    v_exp_f32 v81, v81
    v_exp_f32 v82, v82
    v_exp_f32 v83, v83
    v_cvt_pk_bf16_f32 v144, v80, v81
    v_mfma_f32_32x32x16_bf16 v[176:191], v[76:79], v[156:159], v[176:191]
    v_exp_f32 v84, v84
    v_cvt_pk_bf16_f32 v145, v82, v83
    v_exp_f32 v85, v85
    v_exp_f32 v86, v86
    v_exp_f32 v87, v87
    v_cvt_pk_bf16_f32 v146, v84, v85
    v_cvt_pk_bf16_f32 v147, v86, v87
    s_waitcnt lgkmcnt(2)
    v_mfma_f32_32x32x16_bf16 v[96:111], v[52:55], v[32:35], 0
    v_exp_f32 v88, v88
    v_exp_f32 v89, v89
    v_exp_f32 v90, v90
    v_exp_f32 v91, v91
    v_cvt_pk_bf16_f32 v148, v88, v89
    v_mfma_f32_32x32x16_bf16 v[96:111], v[60:63], v[40:43], v[96:111]
    v_exp_f32 v92, v92
    v_cvt_pk_bf16_f32 v149, v90, v91
    v_exp_f32 v93, v93
    v_exp_f32 v94, v94
    v_exp_f32 v95, v95
    v_cvt_pk_bf16_f32 v150, v92, v93
    v_cvt_pk_bf16_f32 v151, v94, v95
    ds_read_b64_tr_b16 v[48:49], v1 offset:11840
    ds_read_b64_tr_b16 v[50:51], v1 offset:13120
    ds_read_b64_tr_b16 v[56:57], v2 offset:11840
    s_waitcnt lgkmcnt(3)
    v_mfma_f32_32x32x16_bf16 v[160:175], v[64:67], v[144:147], v[160:175]
    v_exp_f32 v112, v112
    v_exp_f32 v113, v113
    v_exp_f32 v114, v114
    v_exp_f32 v115, v115
    v_cvt_pk_bf16_f32 v152, v112, v113
    v_mfma_f32_32x32x16_bf16 v[160:175], v[68:71], v[148:151], v[160:175]
    v_exp_f32 v116, v116
    v_cvt_pk_bf16_f32 v153, v114, v115
    v_exp_f32 v117, v117
    v_exp_f32 v118, v118
    v_exp_f32 v119, v119
    v_cvt_pk_bf16_f32 v154, v116, v117
    v_cvt_pk_bf16_f32 v155, v118, v119
    v_mfma_f32_32x32x16_bf16 v[128:143], v[52:55], v[36:39], 0
    v_exp_f32 v120, v120
    v_exp_f32 v121, v121
    v_exp_f32 v122, v122
    v_exp_f32 v123, v123
    v_cvt_pk_bf16_f32 v156, v120, v121
    v_mfma_f32_32x32x16_bf16 v[128:143], v[60:63], v[44:47], v[128:143]
    v_exp_f32 v124, v124
    v_cvt_pk_bf16_f32 v157, v122, v123
    v_exp_f32 v125, v125
    v_exp_f32 v126, v126
    v_exp_f32 v127, v127
    v_cvt_pk_bf16_f32 v158, v124, v125
    v_cvt_pk_bf16_f32 v159, v126, v127
    ds_read_b128 v[72:75], v3 offset:192
    ds_read_b128 v[76:79], v3 offset:224
    v_mfma_f32_32x32x16_bf16 v[176:191], v[64:67], v[152:155], v[176:191]
    v_exp_f32 v96, v96
    v_exp_f32 v97, v97
    v_exp_f32 v98, v98
    v_exp_f32 v99, v99
    v_cvt_pk_bf16_f32 v144, v96, v97
    v_mfma_f32_32x32x16_bf16 v[176:191], v[68:71], v[156:159], v[176:191]
    v_exp_f32 v100, v100
    v_cvt_pk_bf16_f32 v145, v98, v99
    v_exp_f32 v101, v101
    v_exp_f32 v102, v102
    v_exp_f32 v103, v103
    v_cvt_pk_bf16_f32 v146, v100, v101
    v_cvt_pk_bf16_f32 v147, v102, v103
    s_waitcnt lgkmcnt(2)
    v_mfma_f32_32x32x16_bf16 v[80:95], v[48:51], v[32:35], 0
    v_exp_f32 v104, v104
    v_exp_f32 v105, v105
    v_exp_f32 v106, v106
    v_exp_f32 v107, v107
    v_cvt_pk_bf16_f32 v148, v104, v105
    v_mfma_f32_32x32x16_bf16 v[80:95], v[56:59], v[40:43], v[80:95]
    v_exp_f32 v108, v108
    v_cvt_pk_bf16_f32 v149, v106, v107
    v_exp_f32 v109, v109
    v_exp_f32 v110, v110
    v_exp_f32 v111, v111
    v_cvt_pk_bf16_f32 v150, v108, v109
    v_cvt_pk_bf16_f32 v151, v110, v111
    ds_read_b64_tr_b16 v[52:53], v1 offset:11904
    ds_read_b64_tr_b16 v[54:55], v1 offset:13184
    ds_read_b64_tr_b16 v[60:61], v2 offset:11904
    s_waitcnt lgkmcnt(3)
    v_mfma_f32_32x32x16_bf16 v[160:175], v[72:75], v[144:147], v[160:175]
    v_exp_f32 v128, v128
    v_exp_f32 v129, v129
    v_exp_f32 v130, v130
    v_exp_f32 v131, v131
    v_cvt_pk_bf16_f32 v152, v128, v129
    v_mfma_f32_32x32x16_bf16 v[160:175], v[76:79], v[148:151], v[160:175]
    v_exp_f32 v132, v132
    v_cvt_pk_bf16_f32 v153, v130, v131
    v_exp_f32 v133, v133
    v_exp_f32 v134, v134
    v_exp_f32 v135, v135
    v_cvt_pk_bf16_f32 v154, v132, v133
    v_cvt_pk_bf16_f32 v155, v134, v135
    v_mfma_f32_32x32x16_bf16 v[112:127], v[48:51], v[36:39], 0
    v_exp_f32 v136, v136
    v_exp_f32 v137, v137
    v_exp_f32 v138, v138
    v_exp_f32 v139, v139
    v_cvt_pk_bf16_f32 v156, v136, v137
    v_mfma_f32_32x32x16_bf16 v[112:127], v[56:59], v[44:47], v[112:127]
    v_exp_f32 v140, v140
    v_cvt_pk_bf16_f32 v157, v138, v139
    v_exp_f32 v141, v141
    v_exp_f32 v142, v142
    v_exp_f32 v143, v143
    v_cvt_pk_bf16_f32 v158, v140, v141
    v_cvt_pk_bf16_f32 v159, v142, v143
    s_waitcnt vmcnt(0)
    ds_write_b128 v7, v[20:23] offset:23680
    ds_write_b128 v8, v[24:27] offset:23680
    s_mov_b64 exec, s[34:35]
    ds_write_b128 v9, v[28:31] offset:23680
    s_mov_b64 exec, -1
    buffer_load_dwordx4 v[20:23], v4, s[4:7], s28 offen
    buffer_load_dwordx4 v[24:27], v5, s[4:7], s28 offen
    s_mov_b64 exec, s[34:35]
    buffer_load_dwordx4 v[28:31], v6, s[4:7], s28 offen
    s_mov_b64 exec, -1
    s_add_u32 s28, s28, 256
    ds_read_b128 v[64:67], v3 offset:11840
    ds_read_b128 v[68:71], v3 offset:11872
    v_mfma_f32_32x32x16_bf16 v[176:191], v[72:75], v[152:155], v[176:191]
    v_exp_f32 v80, v80
    v_exp_f32 v81, v81
    v_exp_f32 v82, v82
    v_exp_f32 v83, v83
    v_cvt_pk_bf16_f32 v144, v80, v81
    v_mfma_f32_32x32x16_bf16 v[176:191], v[76:79], v[156:159], v[176:191]
    v_exp_f32 v84, v84
    v_cvt_pk_bf16_f32 v145, v82, v83
    v_exp_f32 v85, v85
    v_exp_f32 v86, v86
    v_exp_f32 v87, v87
    v_cvt_pk_bf16_f32 v146, v84, v85
    v_cvt_pk_bf16_f32 v147, v86, v87
    s_waitcnt lgkmcnt(5)
    v_mfma_f32_32x32x16_bf16 v[96:111], v[52:55], v[32:35], 0
    v_exp_f32 v88, v88
    v_exp_f32 v89, v89
    v_exp_f32 v90, v90
    v_exp_f32 v91, v91
    v_cvt_pk_bf16_f32 v148, v88, v89
    v_mfma_f32_32x32x16_bf16 v[96:111], v[60:63], v[40:43], v[96:111]
    v_exp_f32 v92, v92
    v_cvt_pk_bf16_f32 v149, v90, v91
    v_exp_f32 v93, v93
    v_exp_f32 v94, v94
    v_exp_f32 v95, v95
    v_cvt_pk_bf16_f32 v150, v92, v93
    v_cvt_pk_bf16_f32 v151, v94, v95
    ds_read_b64_tr_b16 v[48:49], v1 offset:11968
    ds_read_b64_tr_b16 v[50:51], v1 offset:13248
    ds_read_b64_tr_b16 v[56:57], v2 offset:11968
    s_waitcnt lgkmcnt(3)
    v_mfma_f32_32x32x16_bf16 v[160:175], v[64:67], v[144:147], v[160:175]
    v_exp_f32 v112, v112
    v_exp_f32 v113, v113
    v_exp_f32 v114, v114
    v_exp_f32 v115, v115
    v_cvt_pk_bf16_f32 v152, v112, v113
    v_mfma_f32_32x32x16_bf16 v[160:175], v[68:71], v[148:151], v[160:175]
    v_exp_f32 v116, v116
    v_cvt_pk_bf16_f32 v153, v114, v115
    v_exp_f32 v117, v117
    v_exp_f32 v118, v118
    v_exp_f32 v119, v119
    v_cvt_pk_bf16_f32 v154, v116, v117
    v_cvt_pk_bf16_f32 v155, v118, v119
    v_mfma_f32_32x32x16_bf16 v[128:143], v[52:55], v[36:39], 0
    v_exp_f32 v120, v120
    v_exp_f32 v121, v121
    v_exp_f32 v122, v122
    v_exp_f32 v123, v123
    v_cvt_pk_bf16_f32 v156, v120, v121
    v_mfma_f32_32x32x16_bf16 v[128:143], v[60:63], v[44:47], v[128:143]
    v_exp_f32 v124, v124
    v_cvt_pk_bf16_f32 v157, v122, v123
    v_exp_f32 v125, v125
    v_exp_f32 v126, v126
    v_exp_f32 v127, v127
    v_cvt_pk_bf16_f32 v158, v124, v125
    v_cvt_pk_bf16_f32 v159, v126, v127
    ds_read_b128 v[72:75], v3 offset:11904
    ds_read_b128 v[76:79], v3 offset:11936
    v_mfma_f32_32x32x16_bf16 v[176:191], v[64:67], v[152:155], v[176:191]
    v_exp_f32 v96, v96
    v_exp_f32 v97, v97
    v_exp_f32 v98, v98
    v_exp_f32 v99, v99
    v_cvt_pk_bf16_f32 v144, v96, v97
    v_mfma_f32_32x32x16_bf16 v[176:191], v[68:71], v[156:159], v[176:191]
    v_exp_f32 v100, v100
    v_cvt_pk_bf16_f32 v145, v98, v99
    v_exp_f32 v101, v101
    v_exp_f32 v102, v102
    v_exp_f32 v103, v103
    v_cvt_pk_bf16_f32 v146, v100, v101
    v_cvt_pk_bf16_f32 v147, v102, v103
    s_waitcnt lgkmcnt(2)
    v_mfma_f32_32x32x16_bf16 v[80:95], v[48:51], v[32:35], 0
    v_exp_f32 v104, v104
    v_exp_f32 v105, v105
    v_exp_f32 v106, v106
    v_exp_f32 v107, v107
    v_cvt_pk_bf16_f32 v148, v104, v105
    v_mfma_f32_32x32x16_bf16 v[80:95], v[56:59], v[40:43], v[80:95]
    v_exp_f32 v108, v108
    v_cvt_pk_bf16_f32 v149, v106, v107
    v_exp_f32 v109, v109
    v_exp_f32 v110, v110
    v_exp_f32 v111, v111
    v_cvt_pk_bf16_f32 v150, v108, v109
    v_cvt_pk_bf16_f32 v151, v110, v111
    ds_read_b64_tr_b16 v[52:53], v1 offset:12032
    ds_read_b64_tr_b16 v[54:55], v1 offset:13312
    ds_read_b64_tr_b16 v[60:61], v2 offset:12032
    s_waitcnt lgkmcnt(3)
    v_mfma_f32_32x32x16_bf16 v[160:175], v[72:75], v[144:147], v[160:175]
    v_exp_f32 v128, v128
    v_exp_f32 v129, v129
    v_exp_f32 v130, v130
    v_exp_f32 v131, v131
    v_cvt_pk_bf16_f32 v152, v128, v129
    v_mfma_f32_32x32x16_bf16 v[160:175], v[76:79], v[148:151], v[160:175]
    v_exp_f32 v132, v132
    v_cvt_pk_bf16_f32 v153, v130, v131
    v_exp_f32 v133, v133
    v_exp_f32 v134, v134
    v_exp_f32 v135, v135
    v_cvt_pk_bf16_f32 v154, v132, v133
    v_cvt_pk_bf16_f32 v155, v134, v135
    v_mfma_f32_32x32x16_bf16 v[112:127], v[48:51], v[36:39], 0
    v_exp_f32 v136, v136
    v_exp_f32 v137, v137
    v_exp_f32 v138, v138
    v_exp_f32 v139, v139
    v_cvt_pk_bf16_f32 v156, v136, v137
    v_mfma_f32_32x32x16_bf16 v[112:127], v[56:59], v[44:47], v[112:127]
    v_exp_f32 v140, v140
    v_cvt_pk_bf16_f32 v157, v138, v139
    v_exp_f32 v141, v141
    v_exp_f32 v142, v142
    v_exp_f32 v143, v143
    v_cvt_pk_bf16_f32 v158, v140, v141
    v_cvt_pk_bf16_f32 v159, v142, v143
    s_barrier
    ds_read_b128 v[64:67], v3 offset:11968
    ds_read_b128 v[68:71], v3 offset:12000
    v_mfma_f32_32x32x16_bf16 v[176:191], v[72:75], v[152:155], v[176:191]
    v_exp_f32 v80, v80
    v_exp_f32 v81, v81
    v_exp_f32 v82, v82
    v_exp_f32 v83, v83
    v_cvt_pk_bf16_f32 v144, v80, v81
    v_mfma_f32_32x32x16_bf16 v[176:191], v[76:79], v[156:159], v[176:191]
    v_exp_f32 v84, v84
    v_cvt_pk_bf16_f32 v145, v82, v83
    v_exp_f32 v85, v85
    v_exp_f32 v86, v86
    v_exp_f32 v87, v87
    v_cvt_pk_bf16_f32 v146, v84, v85
    v_cvt_pk_bf16_f32 v147, v86, v87
    s_waitcnt lgkmcnt(2)
    v_mfma_f32_32x32x16_bf16 v[96:111], v[52:55], v[32:35], 0
    v_exp_f32 v88, v88
    v_exp_f32 v89, v89
    v_exp_f32 v90, v90
    v_exp_f32 v91, v91
    v_cvt_pk_bf16_f32 v148, v88, v89
    v_mfma_f32_32x32x16_bf16 v[96:111], v[60:63], v[40:43], v[96:111]
    v_exp_f32 v92, v92
    v_cvt_pk_bf16_f32 v149, v90, v91
    v_exp_f32 v93, v93
    v_exp_f32 v94, v94
    v_exp_f32 v95, v95
    v_cvt_pk_bf16_f32 v150, v92, v93
    v_cvt_pk_bf16_f32 v151, v94, v95
    ds_read_b64_tr_b16 v[48:49], v1 offset:23680
    ds_read_b64_tr_b16 v[50:51], v1 offset:24960
    ds_read_b64_tr_b16 v[56:57], v2 offset:23680
    s_waitcnt lgkmcnt(3)
    v_mfma_f32_32x32x16_bf16 v[160:175], v[64:67], v[144:147], v[160:175]
    v_exp_f32 v112, v112
    v_exp_f32 v113, v113
    v_exp_f32 v114, v114
    v_exp_f32 v115, v115
    v_cvt_pk_bf16_f32 v152, v112, v113
    v_mfma_f32_32x32x16_bf16 v[160:175], v[68:71], v[148:151], v[160:175]
    v_exp_f32 v116, v116
    v_cvt_pk_bf16_f32 v153, v114, v115
    v_exp_f32 v117, v117
    v_exp_f32 v118, v118
    v_exp_f32 v119, v119
    v_cvt_pk_bf16_f32 v154, v116, v117
    v_cvt_pk_bf16_f32 v155, v118, v119
    v_mfma_f32_32x32x16_bf16 v[128:143], v[52:55], v[36:39], 0
    v_exp_f32 v120, v120
    v_exp_f32 v121, v121
    v_exp_f32 v122, v122
    v_exp_f32 v123, v123
    v_cvt_pk_bf16_f32 v156, v120, v121
    v_mfma_f32_32x32x16_bf16 v[128:143], v[60:63], v[44:47], v[128:143]
    v_exp_f32 v124, v124
    v_cvt_pk_bf16_f32 v157, v122, v123
    v_exp_f32 v125, v125
    v_exp_f32 v126, v126
    v_exp_f32 v127, v127
    v_cvt_pk_bf16_f32 v158, v124, v125
    v_cvt_pk_bf16_f32 v159, v126, v127
    ds_read_b128 v[72:75], v3 offset:12032
    ds_read_b128 v[76:79], v3 offset:12064
    v_mfma_f32_32x32x16_bf16 v[176:191], v[64:67], v[152:155], v[176:191]
    v_exp_f32 v96, v96
    v_exp_f32 v97, v97
    v_exp_f32 v98, v98
    v_exp_f32 v99, v99
    v_cvt_pk_bf16_f32 v144, v96, v97
    v_mfma_f32_32x32x16_bf16 v[176:191], v[68:71], v[156:159], v[176:191]
    v_exp_f32 v100, v100
    v_cvt_pk_bf16_f32 v145, v98, v99
    v_exp_f32 v101, v101
    v_exp_f32 v102, v102
    v_exp_f32 v103, v103
    v_cvt_pk_bf16_f32 v146, v100, v101
    v_cvt_pk_bf16_f32 v147, v102, v103
    s_waitcnt lgkmcnt(2)
    v_mfma_f32_32x32x16_bf16 v[80:95], v[48:51], v[32:35], 0
    v_exp_f32 v104, v104
    v_exp_f32 v105, v105
    v_exp_f32 v106, v106
    v_exp_f32 v107, v107
    v_cvt_pk_bf16_f32 v148, v104, v105
    v_mfma_f32_32x32x16_bf16 v[80:95], v[56:59], v[40:43], v[80:95]
    v_exp_f32 v108, v108
    v_cvt_pk_bf16_f32 v149, v106, v107
    v_exp_f32 v109, v109
    v_exp_f32 v110, v110
    v_exp_f32 v111, v111
    v_cvt_pk_bf16_f32 v150, v108, v109
    v_cvt_pk_bf16_f32 v151, v110, v111
    ds_read_b64_tr_b16 v[52:53], v1 offset:23744
    ds_read_b64_tr_b16 v[54:55], v1 offset:25024
    ds_read_b64_tr_b16 v[60:61], v2 offset:23744
    s_waitcnt lgkmcnt(3)
    v_mfma_f32_32x32x16_bf16 v[160:175], v[72:75], v[144:147], v[160:175]
    v_exp_f32 v128, v128
    v_exp_f32 v129, v129
    v_exp_f32 v130, v130
    v_exp_f32 v131, v131
    v_cvt_pk_bf16_f32 v152, v128, v129
    v_mfma_f32_32x32x16_bf16 v[160:175], v[76:79], v[148:151], v[160:175]
    v_exp_f32 v132, v132
    v_cvt_pk_bf16_f32 v153, v130, v131
    v_exp_f32 v133, v133
    v_exp_f32 v134, v134
    v_exp_f32 v135, v135
    v_cvt_pk_bf16_f32 v154, v132, v133
    v_cvt_pk_bf16_f32 v155, v134, v135
    v_mfma_f32_32x32x16_bf16 v[112:127], v[48:51], v[36:39], 0
    v_exp_f32 v136, v136
    v_exp_f32 v137, v137
    v_exp_f32 v138, v138
    v_exp_f32 v139, v139
    v_cvt_pk_bf16_f32 v156, v136, v137
    v_mfma_f32_32x32x16_bf16 v[112:127], v[56:59], v[44:47], v[112:127]
    v_exp_f32 v140, v140
    v_cvt_pk_bf16_f32 v157, v138, v139
    v_exp_f32 v141, v141
    v_exp_f32 v142, v142
    v_exp_f32 v143, v143
    v_cvt_pk_bf16_f32 v158, v140, v141
    v_cvt_pk_bf16_f32 v159, v142, v143
    s_waitcnt vmcnt(0)
    ds_write_b128 v7, v[20:23] offset:35520
    ds_write_b128 v8, v[24:27] offset:35520
    s_mov_b64 exec, s[34:35]
    ds_write_b128 v9, v[28:31] offset:35520
    s_mov_b64 exec, -1
    buffer_load_dwordx4 v[20:23], v4, s[4:7], s28 offen
    buffer_load_dwordx4 v[24:27], v5, s[4:7], s28 offen
    s_mov_b64 exec, s[34:35]
    buffer_load_dwordx4 v[28:31], v6, s[4:7], s28 offen
    s_mov_b64 exec, -1
    s_add_u32 s28, s28, 256
    ds_read_b128 v[64:67], v3 offset:23680
    ds_read_b128 v[68:71], v3 offset:23712
    v_mfma_f32_32x32x16_bf16 v[176:191], v[72:75], v[152:155], v[176:191]
    v_exp_f32 v80, v80
    v_exp_f32 v81, v81
    v_exp_f32 v82, v82
    v_exp_f32 v83, v83
    v_cvt_pk_bf16_f32 v144, v80, v81
    v_mfma_f32_32x32x16_bf16 v[176:191], v[76:79], v[156:159], v[176:191]
    v_exp_f32 v84, v84
    v_cvt_pk_bf16_f32 v145, v82, v83
    v_exp_f32 v85, v85
    v_exp_f32 v86, v86
    v_exp_f32 v87, v87
    v_cvt_pk_bf16_f32 v146, v84, v85
    v_cvt_pk_bf16_f32 v147, v86, v87
    s_waitcnt lgkmcnt(5)
    v_mfma_f32_32x32x16_bf16 v[96:111], v[52:55], v[32:35], 0
    v_exp_f32 v88, v88
    v_exp_f32 v89, v89
    v_exp_f32 v90, v90
    v_exp_f32 v91, v91
    v_cvt_pk_bf16_f32 v148, v88, v89
    v_mfma_f32_32x32x16_bf16 v[96:111], v[60:63], v[40:43], v[96:111]
    v_exp_f32 v92, v92
    v_cvt_pk_bf16_f32 v149, v90, v91
    v_exp_f32 v93, v93
    v_exp_f32 v94, v94
    v_exp_f32 v95, v95
    v_cvt_pk_bf16_f32 v150, v92, v93
    v_cvt_pk_bf16_f32 v151, v94, v95
    ds_read_b64_tr_b16 v[48:49], v1 offset:23808
    ds_read_b64_tr_b16 v[50:51], v1 offset:25088
    ds_read_b64_tr_b16 v[56:57], v2 offset:23808
    s_waitcnt lgkmcnt(3)
    v_mfma_f32_32x32x16_bf16 v[160:175], v[64:67], v[144:147], v[160:175]
    v_exp_f32 v112, v112
    v_exp_f32 v113, v113
    v_exp_f32 v114, v114
    v_exp_f32 v115, v115
    v_cvt_pk_bf16_f32 v152, v112, v113
    v_mfma_f32_32x32x16_bf16 v[160:175], v[68:71], v[148:151], v[160:175]
    v_exp_f32 v116, v116
    v_cvt_pk_bf16_f32 v153, v114, v115
    v_exp_f32 v117, v117
    v_exp_f32 v118, v118
    v_exp_f32 v119, v119
    v_cvt_pk_bf16_f32 v154, v116, v117
    v_cvt_pk_bf16_f32 v155, v118, v119
    v_mfma_f32_32x32x16_bf16 v[128:143], v[52:55], v[36:39], 0
    v_exp_f32 v120, v120
    v_exp_f32 v121, v121
    v_exp_f32 v122, v122
    v_exp_f32 v123, v123
    v_cvt_pk_bf16_f32 v156, v120, v121
    v_mfma_f32_32x32x16_bf16 v[128:143], v[60:63], v[44:47], v[128:143]
    v_exp_f32 v124, v124
    v_cvt_pk_bf16_f32 v157, v122, v123
    v_exp_f32 v125, v125
    v_exp_f32 v126, v126
    v_exp_f32 v127, v127
    v_cvt_pk_bf16_f32 v158, v124, v125
    v_cvt_pk_bf16_f32 v159, v126, v127
    ds_read_b128 v[72:75], v3 offset:23744
    ds_read_b128 v[76:79], v3 offset:23776
    v_mfma_f32_32x32x16_bf16 v[176:191], v[64:67], v[152:155], v[176:191]
    v_exp_f32 v96, v96
    v_exp_f32 v97, v97
    v_exp_f32 v98, v98
    v_exp_f32 v99, v99
    v_cvt_pk_bf16_f32 v144, v96, v97
    v_mfma_f32_32x32x16_bf16 v[176:191], v[68:71], v[156:159], v[176:191]
    v_exp_f32 v100, v100
    v_cvt_pk_bf16_f32 v145, v98, v99
    v_exp_f32 v101, v101
    v_exp_f32 v102, v102
    v_exp_f32 v103, v103
    v_cvt_pk_bf16_f32 v146, v100, v101
    v_cvt_pk_bf16_f32 v147, v102, v103
    s_waitcnt lgkmcnt(2)
    v_mfma_f32_32x32x16_bf16 v[80:95], v[48:51], v[32:35], 0
    v_exp_f32 v104, v104
    v_exp_f32 v105, v105
    v_exp_f32 v106, v106
    v_exp_f32 v107, v107
    v_cvt_pk_bf16_f32 v148, v104, v105
    v_mfma_f32_32x32x16_bf16 v[80:95], v[56:59], v[40:43], v[80:95]
    v_exp_f32 v108, v108
    v_cvt_pk_bf16_f32 v149, v106, v107
    v_exp_f32 v109, v109
    v_exp_f32 v110, v110
    v_exp_f32 v111, v111
    v_cvt_pk_bf16_f32 v150, v108, v109
    v_cvt_pk_bf16_f32 v151, v110, v111
    ds_read_b64_tr_b16 v[52:53], v1 offset:23872
    ds_read_b64_tr_b16 v[54:55], v1 offset:25152
    ds_read_b64_tr_b16 v[60:61], v2 offset:23872
    s_waitcnt lgkmcnt(3)
    v_mfma_f32_32x32x16_bf16 v[160:175], v[72:75], v[144:147], v[160:175]
    v_exp_f32 v128, v128
    v_exp_f32 v129, v129
    v_exp_f32 v130, v130
    v_exp_f32 v131, v131
    v_cvt_pk_bf16_f32 v152, v128, v129
    v_mfma_f32_32x32x16_bf16 v[160:175], v[76:79], v[148:151], v[160:175]
    v_exp_f32 v132, v132
    v_cvt_pk_bf16_f32 v153, v130, v131
    v_exp_f32 v133, v133
    v_exp_f32 v134, v134
    v_exp_f32 v135, v135
    v_cvt_pk_bf16_f32 v154, v132, v133
    v_cvt_pk_bf16_f32 v155, v134, v135
    v_mfma_f32_32x32x16_bf16 v[112:127], v[48:51], v[36:39], 0
    v_exp_f32 v136, v136
    v_exp_f32 v137, v137
    v_exp_f32 v138, v138
    v_exp_f32 v139, v139
    v_cvt_pk_bf16_f32 v156, v136, v137
    v_mfma_f32_32x32x16_bf16 v[112:127], v[56:59], v[44:47], v[112:127]
    v_exp_f32 v140, v140
    v_cvt_pk_bf16_f32 v157, v138, v139
    v_exp_f32 v141, v141
    v_exp_f32 v142, v142
    v_exp_f32 v143, v143
    v_cvt_pk_bf16_f32 v158, v140, v141
    v_cvt_pk_bf16_f32 v159, v142, v143
    s_barrier
    ds_read_b128 v[64:67], v3 offset:23808
    ds_read_b128 v[68:71], v3 offset:23840
    v_mfma_f32_32x32x16_bf16 v[176:191], v[72:75], v[152:155], v[176:191]
    v_exp_f32 v80, v80
    v_exp_f32 v81, v81
    v_exp_f32 v82, v82
    v_exp_f32 v83, v83
    v_cvt_pk_bf16_f32 v144, v80, v81
    v_mfma_f32_32x32x16_bf16 v[176:191], v[76:79], v[156:159], v[176:191]
    v_exp_f32 v84, v84
    v_cvt_pk_bf16_f32 v145, v82, v83
    v_exp_f32 v85, v85
    v_exp_f32 v86, v86
    v_exp_f32 v87, v87
    v_cvt_pk_bf16_f32 v146, v84, v85
    v_cvt_pk_bf16_f32 v147, v86, v87
    s_waitcnt lgkmcnt(2)
    v_mfma_f32_32x32x16_bf16 v[96:111], v[52:55], v[32:35], 0
    v_exp_f32 v88, v88
    v_exp_f32 v89, v89
    v_exp_f32 v90, v90
    v_exp_f32 v91, v91
    v_cvt_pk_bf16_f32 v148, v88, v89
    v_mfma_f32_32x32x16_bf16 v[96:111], v[60:63], v[40:43], v[96:111]
    v_exp_f32 v92, v92
    v_cvt_pk_bf16_f32 v149, v90, v91
    v_exp_f32 v93, v93
    v_exp_f32 v94, v94
    v_exp_f32 v95, v95
    v_cvt_pk_bf16_f32 v150, v92, v93
    v_cvt_pk_bf16_f32 v151, v94, v95
    ds_read_b64_tr_b16 v[48:49], v1 offset:35520
    ds_read_b64_tr_b16 v[50:51], v1 offset:36800
    ds_read_b64_tr_b16 v[56:57], v2 offset:35520
    s_waitcnt lgkmcnt(3)
    v_mfma_f32_32x32x16_bf16 v[160:175], v[64:67], v[144:147], v[160:175]
    v_exp_f32 v112, v112
    v_exp_f32 v113, v113
    v_exp_f32 v114, v114
    v_exp_f32 v115, v115
    v_cvt_pk_bf16_f32 v152, v112, v113
    v_mfma_f32_32x32x16_bf16 v[160:175], v[68:71], v[148:151], v[160:175]
    v_exp_f32 v116, v116
    v_cvt_pk_bf16_f32 v153, v114, v115
    v_exp_f32 v117, v117
    v_exp_f32 v118, v118
    v_exp_f32 v119, v119
    v_cvt_pk_bf16_f32 v154, v116, v117
    v_cvt_pk_bf16_f32 v155, v118, v119
    v_mfma_f32_32x32x16_bf16 v[128:143], v[52:55], v[36:39], 0
    v_exp_f32 v120, v120
    v_exp_f32 v121, v121
    v_exp_f32 v122, v122
    v_exp_f32 v123, v123
    v_cvt_pk_bf16_f32 v156, v120, v121
    v_mfma_f32_32x32x16_bf16 v[128:143], v[60:63], v[44:47], v[128:143]
    v_exp_f32 v124, v124
    v_cvt_pk_bf16_f32 v157, v122, v123
    v_exp_f32 v125, v125
    v_exp_f32 v126, v126
    v_exp_f32 v127, v127
    v_cvt_pk_bf16_f32 v158, v124, v125
    v_cvt_pk_bf16_f32 v159, v126, v127
    ds_read_b128 v[72:75], v3 offset:23872
    ds_read_b128 v[76:79], v3 offset:23904
    v_mfma_f32_32x32x16_bf16 v[176:191], v[64:67], v[152:155], v[176:191]
    v_exp_f32 v96, v96
    v_exp_f32 v97, v97
    v_exp_f32 v98, v98
    v_exp_f32 v99, v99
    v_cvt_pk_bf16_f32 v144, v96, v97
    v_mfma_f32_32x32x16_bf16 v[176:191], v[68:71], v[156:159], v[176:191]
    v_exp_f32 v100, v100
    v_cvt_pk_bf16_f32 v145, v98, v99
    v_exp_f32 v101, v101
    v_exp_f32 v102, v102
    v_exp_f32 v103, v103
    v_cvt_pk_bf16_f32 v146, v100, v101
    v_cvt_pk_bf16_f32 v147, v102, v103
    s_waitcnt lgkmcnt(2)
    v_mfma_f32_32x32x16_bf16 v[80:95], v[48:51], v[32:35], 0
    v_exp_f32 v104, v104
    v_exp_f32 v105, v105
    v_exp_f32 v106, v106
    v_exp_f32 v107, v107
    v_cvt_pk_bf16_f32 v148, v104, v105
    v_mfma_f32_32x32x16_bf16 v[80:95], v[56:59], v[40:43], v[80:95]
    v_exp_f32 v108, v108
    v_cvt_pk_bf16_f32 v149, v106, v107
    v_exp_f32 v109, v109
    v_exp_f32 v110, v110
    v_exp_f32 v111, v111
    v_cvt_pk_bf16_f32 v150, v108, v109
    v_cvt_pk_bf16_f32 v151, v110, v111
    ds_read_b64_tr_b16 v[52:53], v1 offset:35584
    ds_read_b64_tr_b16 v[54:55], v1 offset:36864
    ds_read_b64_tr_b16 v[60:61], v2 offset:35584
    s_waitcnt lgkmcnt(3)
    v_mfma_f32_32x32x16_bf16 v[160:175], v[72:75], v[144:147], v[160:175]
    v_exp_f32 v128, v128
    v_exp_f32 v129, v129
    v_exp_f32 v130, v130
    v_exp_f32 v131, v131
    v_cvt_pk_bf16_f32 v152, v128, v129
    v_mfma_f32_32x32x16_bf16 v[160:175], v[76:79], v[148:151], v[160:175]
    v_exp_f32 v132, v132
    v_cvt_pk_bf16_f32 v153, v130, v131
    v_exp_f32 v133, v133
    v_exp_f32 v134, v134
    v_exp_f32 v135, v135
    v_cvt_pk_bf16_f32 v154, v132, v133
    v_cvt_pk_bf16_f32 v155, v134, v135
    v_mfma_f32_32x32x16_bf16 v[112:127], v[48:51], v[36:39], 0
    v_exp_f32 v136, v136
    v_exp_f32 v137, v137
    v_exp_f32 v138, v138
    v_exp_f32 v139, v139
    v_cvt_pk_bf16_f32 v156, v136, v137
    v_mfma_f32_32x32x16_bf16 v[112:127], v[56:59], v[44:47], v[112:127]
    v_exp_f32 v140, v140
    v_cvt_pk_bf16_f32 v157, v138, v139
    v_exp_f32 v141, v141
    v_exp_f32 v142, v142
    v_exp_f32 v143, v143
    v_cvt_pk_bf16_f32 v158, v140, v141
    v_cvt_pk_bf16_f32 v159, v142, v143
    s_waitcnt vmcnt(0)
    ds_write_b128 v7, v[20:23] offset:0
    ds_write_b128 v8, v[24:27] offset:0
    s_mov_b64 exec, s[34:35]
    ds_write_b128 v9, v[28:31] offset:0
    s_mov_b64 exec, -1
    buffer_load_dwordx4 v[20:23], v4, s[4:7], s28 offen
    buffer_load_dwordx4 v[24:27], v5, s[4:7], s28 offen
    s_mov_b64 exec, s[34:35]
    buffer_load_dwordx4 v[28:31], v6, s[4:7], s28 offen
    s_mov_b64 exec, -1
    s_add_u32 s28, s28, 256
    ds_read_b128 v[64:67], v3 offset:35520
    ds_read_b128 v[68:71], v3 offset:35552
    v_mfma_f32_32x32x16_bf16 v[176:191], v[72:75], v[152:155], v[176:191]
    v_exp_f32 v80, v80
    v_exp_f32 v81, v81
    v_exp_f32 v82, v82
    v_exp_f32 v83, v83
    v_cvt_pk_bf16_f32 v144, v80, v81
    v_mfma_f32_32x32x16_bf16 v[176:191], v[76:79], v[156:159], v[176:191]
    v_exp_f32 v84, v84
    v_cvt_pk_bf16_f32 v145, v82, v83
    v_exp_f32 v85, v85
    v_exp_f32 v86, v86
    v_exp_f32 v87, v87
    v_cvt_pk_bf16_f32 v146, v84, v85
    v_cvt_pk_bf16_f32 v147, v86, v87
    s_waitcnt lgkmcnt(5)
    v_mfma_f32_32x32x16_bf16 v[96:111], v[52:55], v[32:35], 0
    v_exp_f32 v88, v88
    v_exp_f32 v89, v89
    v_exp_f32 v90, v90
    v_exp_f32 v91, v91
    v_cvt_pk_bf16_f32 v148, v88, v89
    v_mfma_f32_32x32x16_bf16 v[96:111], v[60:63], v[40:43], v[96:111]
    v_exp_f32 v92, v92
    v_cvt_pk_bf16_f32 v149, v90, v91
    v_exp_f32 v93, v93
    v_exp_f32 v94, v94
    v_exp_f32 v95, v95
    v_cvt_pk_bf16_f32 v150, v92, v93
    v_cvt_pk_bf16_f32 v151, v94, v95
    ds_read_b64_tr_b16 v[48:49], v1 offset:35648
    ds_read_b64_tr_b16 v[50:51], v1 offset:36928
    ds_read_b64_tr_b16 v[56:57], v2 offset:35648
    s_waitcnt lgkmcnt(3)
    v_mfma_f32_32x32x16_bf16 v[160:175], v[64:67], v[144:147], v[160:175]
    v_exp_f32 v112, v112
    v_exp_f32 v113, v113
    v_exp_f32 v114, v114
    v_exp_f32 v115, v115
    v_cvt_pk_bf16_f32 v152, v112, v113
    v_mfma_f32_32x32x16_bf16 v[160:175], v[68:71], v[148:151], v[160:175]
    v_exp_f32 v116, v116
    v_cvt_pk_bf16_f32 v153, v114, v115
    v_exp_f32 v117, v117
    v_exp_f32 v118, v118
    v_exp_f32 v119, v119
    v_cvt_pk_bf16_f32 v154, v116, v117
    v_cvt_pk_bf16_f32 v155, v118, v119
    v_mfma_f32_32x32x16_bf16 v[128:143], v[52:55], v[36:39], 0
    v_exp_f32 v120, v120
    v_exp_f32 v121, v121
    v_exp_f32 v122, v122
    v_exp_f32 v123, v123
    v_cvt_pk_bf16_f32 v156, v120, v121
    v_mfma_f32_32x32x16_bf16 v[128:143], v[60:63], v[44:47], v[128:143]
    v_exp_f32 v124, v124
    v_cvt_pk_bf16_f32 v157, v122, v123
    v_exp_f32 v125, v125
    v_exp_f32 v126, v126
    v_exp_f32 v127, v127
    v_cvt_pk_bf16_f32 v158, v124, v125
    v_cvt_pk_bf16_f32 v159, v126, v127
    ds_read_b128 v[72:75], v3 offset:35584
    ds_read_b128 v[76:79], v3 offset:35616
    v_mfma_f32_32x32x16_bf16 v[176:191], v[64:67], v[152:155], v[176:191]
    v_exp_f32 v96, v96
    v_exp_f32 v97, v97
    v_exp_f32 v98, v98
    v_exp_f32 v99, v99
    v_cvt_pk_bf16_f32 v144, v96, v97
    v_mfma_f32_32x32x16_bf16 v[176:191], v[68:71], v[156:159], v[176:191]
    v_exp_f32 v100, v100
    v_cvt_pk_bf16_f32 v145, v98, v99
    v_exp_f32 v101, v101
    v_exp_f32 v102, v102
    v_exp_f32 v103, v103
    v_cvt_pk_bf16_f32 v146, v100, v101
    v_cvt_pk_bf16_f32 v147, v102, v103
    s_waitcnt lgkmcnt(2)
    v_mfma_f32_32x32x16_bf16 v[80:95], v[48:51], v[32:35], 0
    v_exp_f32 v104, v104
    v_exp_f32 v105, v105
    v_exp_f32 v106, v106
    v_exp_f32 v107, v107
    v_cvt_pk_bf16_f32 v148, v104, v105
    v_mfma_f32_32x32x16_bf16 v[80:95], v[56:59], v[40:43], v[80:95]
    v_exp_f32 v108, v108
    v_cvt_pk_bf16_f32 v149, v106, v107
    v_exp_f32 v109, v109
    v_exp_f32 v110, v110
    v_exp_f32 v111, v111
    v_cvt_pk_bf16_f32 v150, v108, v109
    v_cvt_pk_bf16_f32 v151, v110, v111
    ds_read_b64_tr_b16 v[52:53], v1 offset:35712
    ds_read_b64_tr_b16 v[54:55], v1 offset:36992
    ds_read_b64_tr_b16 v[60:61], v2 offset:35712
    s_waitcnt lgkmcnt(3)
    v_mfma_f32_32x32x16_bf16 v[160:175], v[72:75], v[144:147], v[160:175]
    v_exp_f32 v128, v128
    v_exp_f32 v129, v129
    v_exp_f32 v130, v130
    v_exp_f32 v131, v131
    v_cvt_pk_bf16_f32 v152, v128, v129
    v_mfma_f32_32x32x16_bf16 v[160:175], v[76:79], v[148:151], v[160:175]
    v_exp_f32 v132, v132
    v_cvt_pk_bf16_f32 v153, v130, v131
    v_exp_f32 v133, v133
    v_exp_f32 v134, v134
    v_exp_f32 v135, v135
    v_cvt_pk_bf16_f32 v154, v132, v133
    v_cvt_pk_bf16_f32 v155, v134, v135
    v_mfma_f32_32x32x16_bf16 v[112:127], v[48:51], v[36:39], 0
    v_exp_f32 v136, v136
    v_exp_f32 v137, v137
    v_exp_f32 v138, v138
    v_exp_f32 v139, v139
    v_cvt_pk_bf16_f32 v156, v136, v137
    v_mfma_f32_32x32x16_bf16 v[112:127], v[56:59], v[44:47], v[112:127]
    v_exp_f32 v140, v140
    v_cvt_pk_bf16_f32 v157, v138, v139
    v_exp_f32 v141, v141
    v_exp_f32 v142, v142
    v_exp_f32 v143, v143
    v_cvt_pk_bf16_f32 v158, v140, v141
    v_cvt_pk_bf16_f32 v159, v142, v143
    s_barrier
    ds_read_b128 v[64:67], v3 offset:35648
    ds_read_b128 v[68:71], v3 offset:35680
    v_mfma_f32_32x32x16_bf16 v[176:191], v[72:75], v[152:155], v[176:191]
    v_exp_f32 v80, v80
    v_exp_f32 v81, v81
    v_exp_f32 v82, v82
    v_exp_f32 v83, v83
    v_cvt_pk_bf16_f32 v144, v80, v81
    v_mfma_f32_32x32x16_bf16 v[176:191], v[76:79], v[156:159], v[176:191]
    v_exp_f32 v84, v84
    v_cvt_pk_bf16_f32 v145, v82, v83
    v_exp_f32 v85, v85
    v_exp_f32 v86, v86
    v_exp_f32 v87, v87
    v_cvt_pk_bf16_f32 v146, v84, v85
    v_cvt_pk_bf16_f32 v147, v86, v87
    s_waitcnt lgkmcnt(2)
    v_mfma_f32_32x32x16_bf16 v[96:111], v[52:55], v[32:35], 0
    v_exp_f32 v88, v88
    v_exp_f32 v89, v89
    v_exp_f32 v90, v90
    v_exp_f32 v91, v91
    v_cvt_pk_bf16_f32 v148, v88, v89
    v_mfma_f32_32x32x16_bf16 v[96:111], v[60:63], v[40:43], v[96:111]
    v_exp_f32 v92, v92
    v_cvt_pk_bf16_f32 v149, v90, v91
    v_exp_f32 v93, v93
    v_exp_f32 v94, v94
    v_exp_f32 v95, v95
    v_cvt_pk_bf16_f32 v150, v92, v93
    v_cvt_pk_bf16_f32 v151, v94, v95
    ds_read_b64_tr_b16 v[48:49], v1 offset:0
    ds_read_b64_tr_b16 v[50:51], v1 offset:1280
    ds_read_b64_tr_b16 v[56:57], v2 offset:0
    s_waitcnt lgkmcnt(3)
    v_mfma_f32_32x32x16_bf16 v[160:175], v[64:67], v[144:147], v[160:175]
    v_exp_f32 v112, v112
    v_exp_f32 v113, v113
    v_exp_f32 v114, v114
    v_exp_f32 v115, v115
    v_cvt_pk_bf16_f32 v152, v112, v113
    v_mfma_f32_32x32x16_bf16 v[160:175], v[68:71], v[148:151], v[160:175]
    v_exp_f32 v116, v116
    v_cvt_pk_bf16_f32 v153, v114, v115
    v_exp_f32 v117, v117
    v_exp_f32 v118, v118
    v_exp_f32 v119, v119
    v_cvt_pk_bf16_f32 v154, v116, v117
    v_cvt_pk_bf16_f32 v155, v118, v119
    v_mfma_f32_32x32x16_bf16 v[128:143], v[52:55], v[36:39], 0
    v_exp_f32 v120, v120
    v_exp_f32 v121, v121
    v_exp_f32 v122, v122
    v_exp_f32 v123, v123
    v_cvt_pk_bf16_f32 v156, v120, v121
    v_mfma_f32_32x32x16_bf16 v[128:143], v[60:63], v[44:47], v[128:143]
    v_exp_f32 v124, v124
    v_cvt_pk_bf16_f32 v157, v122, v123
    v_exp_f32 v125, v125
    v_exp_f32 v126, v126
    v_exp_f32 v127, v127
    v_cvt_pk_bf16_f32 v158, v124, v125
    v_cvt_pk_bf16_f32 v159, v126, v127
    ds_read_b128 v[72:75], v3 offset:35712
    ds_read_b128 v[76:79], v3 offset:35744
    v_mfma_f32_32x32x16_bf16 v[176:191], v[64:67], v[152:155], v[176:191]
    v_exp_f32 v96, v96
    v_exp_f32 v97, v97
    v_exp_f32 v98, v98
    v_exp_f32 v99, v99
    v_cvt_pk_bf16_f32 v144, v96, v97
    v_mfma_f32_32x32x16_bf16 v[176:191], v[68:71], v[156:159], v[176:191]
    v_exp_f32 v100, v100
    v_cvt_pk_bf16_f32 v145, v98, v99
    v_exp_f32 v101, v101
    v_exp_f32 v102, v102
    v_exp_f32 v103, v103
    v_cvt_pk_bf16_f32 v146, v100, v101
    v_cvt_pk_bf16_f32 v147, v102, v103
    s_waitcnt lgkmcnt(2)
    v_mfma_f32_32x32x16_bf16 v[80:95], v[48:51], v[32:35], 0
    v_exp_f32 v104, v104
    v_exp_f32 v105, v105
    v_exp_f32 v106, v106
    v_exp_f32 v107, v107
    v_cvt_pk_bf16_f32 v148, v104, v105
    v_mfma_f32_32x32x16_bf16 v[80:95], v[56:59], v[40:43], v[80:95]
    v_exp_f32 v108, v108
    v_cvt_pk_bf16_f32 v149, v106, v107
    v_exp_f32 v109, v109
    v_exp_f32 v110, v110
    v_exp_f32 v111, v111
    v_cvt_pk_bf16_f32 v150, v108, v109
    v_cvt_pk_bf16_f32 v151, v110, v111
    ds_read_b64_tr_b16 v[52:53], v1 offset:64
    ds_read_b64_tr_b16 v[54:55], v1 offset:1344
    ds_read_b64_tr_b16 v[60:61], v2 offset:64
    s_waitcnt lgkmcnt(3)
    v_mfma_f32_32x32x16_bf16 v[160:175], v[72:75], v[144:147], v[160:175]
    v_exp_f32 v128, v128
    v_exp_f32 v129, v129
    v_exp_f32 v130, v130
    v_exp_f32 v131, v131
    v_cvt_pk_bf16_f32 v152, v128, v129
    v_mfma_f32_32x32x16_bf16 v[160:175], v[76:79], v[148:151], v[160:175]
    v_exp_f32 v132, v132
    v_cvt_pk_bf16_f32 v153, v130, v131
    v_exp_f32 v133, v133
    v_exp_f32 v134, v134
    v_exp_f32 v135, v135
    v_cvt_pk_bf16_f32 v154, v132, v133
    v_cvt_pk_bf16_f32 v155, v134, v135
    v_mfma_f32_32x32x16_bf16 v[112:127], v[48:51], v[36:39], 0
    v_exp_f32 v136, v136
    v_exp_f32 v137, v137
    v_exp_f32 v138, v138
    v_exp_f32 v139, v139
    v_cvt_pk_bf16_f32 v156, v136, v137
    v_mfma_f32_32x32x16_bf16 v[112:127], v[56:59], v[44:47], v[112:127]
    v_exp_f32 v140, v140
    v_cvt_pk_bf16_f32 v157, v138, v139
    v_exp_f32 v141, v141
    v_exp_f32 v142, v142
    v_exp_f32 v143, v143
    v_cvt_pk_bf16_f32 v158, v140, v141
    v_cvt_pk_bf16_f32 v159, v142, v143
    s_add_u32 s29, s29, 1
    s_cmp_lt_u32 s29, 4
    s_nop 2
    s_cbranch_scc1 ALOOP_15
    v_mfma_f32_32x32x16_bf16 v[176:191], v[72:75], v[152:155], v[176:191]
    v_mfma_f32_32x32x16_bf16 v[176:191], v[76:79], v[156:159], v[176:191]
    s_waitcnt vmcnt(0) lgkmcnt(0)
    s_cmp_lg_u32 s36, 0
    s_cbranch_scc1 ASTORE_13
    s_mov_b64 s[38:39], 0
    v_mul_f32 v10, 0, v160
    v_fma_f32 v10, v161, 0, v10
    v_fma_f32 v10, v162, 0, v10
    v_fma_f32 v10, v163, 0, v10
    v_fma_f32 v10, v164, 0, v10
    v_fma_f32 v10, v165, 0, v10
    v_fma_f32 v10, v166, 0, v10
    v_fma_f32 v10, v167, 0, v10
    v_fma_f32 v10, v168, 0, v10
    v_fma_f32 v10, v169, 0, v10
    v_fma_f32 v10, v170, 0, v10
    v_cmp_eq_f32 vcc, 0, v10
    s_andn2_b64 s[40:41], exec, vcc
    s_or_b64 s[38:39], s[38:39], s[40:41]
    v_mov_b32 v11, 0x71800000
    v_cmp_lt_f32 vcc, v170, v11
    s_andn2_b64 s[40:41], exec, vcc
    s_or_b64 s[38:39], s[38:39], s[40:41]
    v_mul_f32 v10, 0, v176
    v_fma_f32 v10, v177, 0, v10
    v_fma_f32 v10, v178, 0, v10
    v_fma_f32 v10, v179, 0, v10
    v_fma_f32 v10, v180, 0, v10
    v_fma_f32 v10, v181, 0, v10
    v_fma_f32 v10, v182, 0, v10
    v_fma_f32 v10, v183, 0, v10
    v_fma_f32 v10, v184, 0, v10
    v_fma_f32 v10, v185, 0, v10
    v_fma_f32 v10, v186, 0, v10
    v_cmp_eq_f32 vcc, 0, v10
    s_andn2_b64 s[40:41], exec, vcc
    s_or_b64 s[38:39], s[38:39], s[40:41]
    v_mov_b32 v11, 0x71800000
    v_cmp_lt_f32 vcc, v186, v11
    s_andn2_b64 s[40:41], exec, vcc
    s_or_b64 s[38:39], s[38:39], s[40:41]
    s_cmp_lg_u64 s[38:39], 0
    s_cselect_b32 s38, 1, 0
    v_mov_b32 v10, s38
    v_lshrrev_b32 v11, 6, v0
    v_lshlrev_b32 v11, 2, v11
    ds_write_b32 v11, v10 offset:256
    s_waitcnt lgkmcnt(0)
    s_barrier
    v_mov_b32 v11, 0
    ds_read_b128 v[80:83], v11 offset:256
    s_waitcnt lgkmcnt(0)
    v_or_b32 v10, v80, v81
    v_or3_b32 v10, v10, v82, v83
    s_nop 0
    v_readfirstlane_b32 s38, v10
    s_cmp_lg_u32 s38, 0
    s_cbranch_scc1 AFALL_12
    s_nop 2
ASTORE_13:
    v_bfe_u32 v10, v0, 5, 1
    v_lshl_add_u32 v16, v10, 3, v16
    s_mul_i32 s31, s26, 36
    v_mov_b32 v11, v170
    v_mov_b32 v12, v170
    s_nop 1
    v_permlane32_swap_b32 v11, v12
    v_rcp_f32 v11, v11
    s_nop 0
    v_mul_f32 v160, v11, v160
    v_mul_f32 v161, v11, v161
    v_mul_f32 v162, v11, v162
    v_mul_f32 v163, v11, v163
    v_mul_f32 v164, v11, v164
    v_mul_f32 v165, v11, v165
    v_mul_f32 v166, v11, v166
    v_mul_f32 v167, v11, v167
    v_mul_f32 v168, v11, v168
    v_mul_f32 v169, v11, v169
    v_cvt_pk_bf16_f32 v160, v160, v161
    v_cvt_pk_bf16_f32 v161, v162, v163
    v_cvt_pk_bf16_f32 v162, v164, v165
    v_cvt_pk_bf16_f32 v163, v166, v167
    v_cvt_pk_bf16_f32 v164, v168, v169
    buffer_store_dwordx2 v[160:161], v16, s[8:11], s31 offen
    buffer_store_dwordx2 v[162:163], v16, s[8:11], s31 offen offset:16
    s_mov_b64 exec, s[32:33]
    buffer_store_dword v164, v16, s[8:11], s31 offen offset:32
    s_mov_b64 exec, -1
    s_add_u32 s31, s31, 36864
    v_mov_b32 v11, v186
    v_mov_b32 v12, v186
    s_nop 1
    v_permlane32_swap_b32 v11, v12
    v_rcp_f32 v11, v11
    s_nop 0
    v_mul_f32 v176, v11, v176
    v_mul_f32 v177, v11, v177
    v_mul_f32 v178, v11, v178
    v_mul_f32 v179, v11, v179
    v_mul_f32 v180, v11, v180
    v_mul_f32 v181, v11, v181
    v_mul_f32 v182, v11, v182
    v_mul_f32 v183, v11, v183
    v_mul_f32 v184, v11, v184
    v_mul_f32 v185, v11, v185
    v_cvt_pk_bf16_f32 v176, v176, v177
    v_cvt_pk_bf16_f32 v177, v178, v179
    v_cvt_pk_bf16_f32 v178, v180, v181
    v_cvt_pk_bf16_f32 v179, v182, v183
    v_cvt_pk_bf16_f32 v180, v184, v185
    buffer_store_dwordx2 v[176:177], v16, s[8:11], s31 offen
    buffer_store_dwordx2 v[178:179], v16, s[8:11], s31 offen offset:16
    s_mov_b64 exec, s[32:33]
    buffer_store_dword v180, v16, s[8:11], s31 offen offset:32
    s_mov_b64 exec, -1
    s_add_u32 s31, s31, 36864
    s_endpgm
AFALL_12:
    s_barrier
    v_mov_b32 v41, 0
    v_mov_b32 v160, 0xff800000
    v_mov_b32 v45, 0
    v_mov_b32 v176, 0xff800000
    s_mov_b32 s28, 0
    buffer_load_dwordx4 v[20:23], v4, s[4:7], s28 offen
    buffer_load_dwordx4 v[24:27], v5, s[4:7], s28 offen
    s_mov_b64 exec, s[34:35]
    buffer_load_dwordx4 v[28:31], v6, s[4:7], s28 offen
    s_mov_b64 exec, -1
    s_add_u32 s28, s28, 256
    s_waitcnt vmcnt(0)
    ds_write_b128 v7, v[20:23] offset:0
    ds_write_b128 v8, v[24:27] offset:0
    s_mov_b64 exec, s[34:35]
    ds_write_b128 v9, v[28:31] offset:0
    s_mov_b64 exec, -1
    buffer_load_dwordx4 v[20:23], v4, s[4:7], s28 offen
    buffer_load_dwordx4 v[24:27], v5, s[4:7], s28 offen
    s_mov_b64 exec, s[34:35]
    buffer_load_dwordx4 v[28:31], v6, s[4:7], s28 offen
    s_mov_b64 exec, -1
    s_add_u32 s28, s28, 256
    s_waitcnt lgkmcnt(0)
    s_barrier
    ds_read_b64_tr_b16 v[48:49], v1 offset:0
    ds_read_b64_tr_b16 v[50:51], v1 offset:1280
    ds_read_b64_tr_b16 v[56:57], v2 offset:0
    ds_read_b64_tr_b16 v[52:53], v1 offset:64
    ds_read_b64_tr_b16 v[54:55], v1 offset:1344
    ds_read_b64_tr_b16 v[60:61], v2 offset:64
    s_mov_b32 s29, 0
AMAX_16:
    s_waitcnt vmcnt(0)
    ds_write_b128 v7, v[20:23] offset:11840
    ds_write_b128 v8, v[24:27] offset:11840
    s_mov_b64 exec, s[34:35]
    ds_write_b128 v9, v[28:31] offset:11840
    s_mov_b64 exec, -1
    buffer_load_dwordx4 v[20:23], v4, s[4:7], s28 offen
    buffer_load_dwordx4 v[24:27], v5, s[4:7], s28 offen
    s_mov_b64 exec, s[34:35]
    buffer_load_dwordx4 v[28:31], v6, s[4:7], s28 offen
    s_mov_b64 exec, -1
    s_add_u32 s28, s28, 256
    s_waitcnt lgkmcnt(6)
    v_mfma_f32_32x32x16_bf16 v[80:95], v[48:51], v[32:35], 0
    v_mfma_f32_32x32x16_bf16 v[80:95], v[56:59], v[40:43], v[80:95]
    v_mfma_f32_32x32x16_bf16 v[112:127], v[48:51], v[36:39], 0
    v_mfma_f32_32x32x16_bf16 v[112:127], v[56:59], v[44:47], v[112:127]
    s_nop 9
    v_max3_f32 v160, v160, v80, v81
    v_max3_f32 v160, v160, v82, v83
    v_max3_f32 v160, v160, v84, v85
    v_max3_f32 v160, v160, v86, v87
    v_max3_f32 v160, v160, v88, v89
    v_max3_f32 v160, v160, v90, v91
    v_max3_f32 v160, v160, v92, v93
    v_max3_f32 v160, v160, v94, v95
    v_max3_f32 v176, v176, v112, v113
    v_max3_f32 v176, v176, v114, v115
    v_max3_f32 v176, v176, v116, v117
    v_max3_f32 v176, v176, v118, v119
    v_max3_f32 v176, v176, v120, v121
    v_max3_f32 v176, v176, v122, v123
    v_max3_f32 v176, v176, v124, v125
    v_max3_f32 v176, v176, v126, v127
    ds_read_b64_tr_b16 v[48:49], v1 offset:128
    ds_read_b64_tr_b16 v[50:51], v1 offset:1408
    ds_read_b64_tr_b16 v[56:57], v2 offset:128
    s_waitcnt lgkmcnt(6)
    v_mfma_f32_32x32x16_bf16 v[80:95], v[52:55], v[32:35], 0
    v_mfma_f32_32x32x16_bf16 v[80:95], v[60:63], v[40:43], v[80:95]
    v_mfma_f32_32x32x16_bf16 v[112:127], v[52:55], v[36:39], 0
    v_mfma_f32_32x32x16_bf16 v[112:127], v[60:63], v[44:47], v[112:127]
    s_nop 9
    v_max3_f32 v160, v160, v80, v81
    v_max3_f32 v160, v160, v82, v83
    v_max3_f32 v160, v160, v84, v85
    v_max3_f32 v160, v160, v86, v87
    v_max3_f32 v160, v160, v88, v89
    v_max3_f32 v160, v160, v90, v91
    v_max3_f32 v160, v160, v92, v93
    v_max3_f32 v160, v160, v94, v95
    v_max3_f32 v176, v176, v112, v113
    v_max3_f32 v176, v176, v114, v115
    v_max3_f32 v176, v176, v116, v117
    v_max3_f32 v176, v176, v118, v119
    v_max3_f32 v176, v176, v120, v121
    v_max3_f32 v176, v176, v122, v123
    v_max3_f32 v176, v176, v124, v125
    v_max3_f32 v176, v176, v126, v127
    ds_read_b64_tr_b16 v[52:53], v1 offset:192
    ds_read_b64_tr_b16 v[54:55], v1 offset:1472
    ds_read_b64_tr_b16 v[60:61], v2 offset:192
    s_waitcnt lgkmcnt(6)
    s_barrier
    s_waitcnt lgkmcnt(3)
    v_mfma_f32_32x32x16_bf16 v[80:95], v[48:51], v[32:35], 0
    v_mfma_f32_32x32x16_bf16 v[80:95], v[56:59], v[40:43], v[80:95]
    v_mfma_f32_32x32x16_bf16 v[112:127], v[48:51], v[36:39], 0
    v_mfma_f32_32x32x16_bf16 v[112:127], v[56:59], v[44:47], v[112:127]
    s_nop 9
    v_max3_f32 v160, v160, v80, v81
    v_max3_f32 v160, v160, v82, v83
    v_max3_f32 v160, v160, v84, v85
    v_max3_f32 v160, v160, v86, v87
    v_max3_f32 v160, v160, v88, v89
    v_max3_f32 v160, v160, v90, v91
    v_max3_f32 v160, v160, v92, v93
    v_max3_f32 v160, v160, v94, v95
    v_max3_f32 v176, v176, v112, v113
    v_max3_f32 v176, v176, v114, v115
    v_max3_f32 v176, v176, v116, v117
    v_max3_f32 v176, v176, v118, v119
    v_max3_f32 v176, v176, v120, v121
    v_max3_f32 v176, v176, v122, v123
    v_max3_f32 v176, v176, v124, v125
    v_max3_f32 v176, v176, v126, v127
    ds_read_b64_tr_b16 v[48:49], v1 offset:11840
    ds_read_b64_tr_b16 v[50:51], v1 offset:13120
    ds_read_b64_tr_b16 v[56:57], v2 offset:11840
    s_waitcnt lgkmcnt(3)
    v_mfma_f32_32x32x16_bf16 v[80:95], v[52:55], v[32:35], 0
    v_mfma_f32_32x32x16_bf16 v[80:95], v[60:63], v[40:43], v[80:95]
    v_mfma_f32_32x32x16_bf16 v[112:127], v[52:55], v[36:39], 0
    v_mfma_f32_32x32x16_bf16 v[112:127], v[60:63], v[44:47], v[112:127]
    s_nop 9
    v_max3_f32 v160, v160, v80, v81
    v_max3_f32 v160, v160, v82, v83
    v_max3_f32 v160, v160, v84, v85
    v_max3_f32 v160, v160, v86, v87
    v_max3_f32 v160, v160, v88, v89
    v_max3_f32 v160, v160, v90, v91
    v_max3_f32 v160, v160, v92, v93
    v_max3_f32 v160, v160, v94, v95
    v_max3_f32 v176, v176, v112, v113
    v_max3_f32 v176, v176, v114, v115
    v_max3_f32 v176, v176, v116, v117
    v_max3_f32 v176, v176, v118, v119
    v_max3_f32 v176, v176, v120, v121
    v_max3_f32 v176, v176, v122, v123
    v_max3_f32 v176, v176, v124, v125
    v_max3_f32 v176, v176, v126, v127
    ds_read_b64_tr_b16 v[52:53], v1 offset:11904
    ds_read_b64_tr_b16 v[54:55], v1 offset:13184
    ds_read_b64_tr_b16 v[60:61], v2 offset:11904
    s_waitcnt vmcnt(0)
    ds_write_b128 v7, v[20:23] offset:23680
    ds_write_b128 v8, v[24:27] offset:23680
    s_mov_b64 exec, s[34:35]
    ds_write_b128 v9, v[28:31] offset:23680
    s_mov_b64 exec, -1
    buffer_load_dwordx4 v[20:23], v4, s[4:7], s28 offen
    buffer_load_dwordx4 v[24:27], v5, s[4:7], s28 offen
    s_mov_b64 exec, s[34:35]
    buffer_load_dwordx4 v[28:31], v6, s[4:7], s28 offen
    s_mov_b64 exec, -1
    s_add_u32 s28, s28, 256
    s_waitcnt lgkmcnt(6)
    v_mfma_f32_32x32x16_bf16 v[80:95], v[48:51], v[32:35], 0
    v_mfma_f32_32x32x16_bf16 v[80:95], v[56:59], v[40:43], v[80:95]
    v_mfma_f32_32x32x16_bf16 v[112:127], v[48:51], v[36:39], 0
    v_mfma_f32_32x32x16_bf16 v[112:127], v[56:59], v[44:47], v[112:127]
    s_nop 9
    v_max3_f32 v160, v160, v80, v81
    v_max3_f32 v160, v160, v82, v83
    v_max3_f32 v160, v160, v84, v85
    v_max3_f32 v160, v160, v86, v87
    v_max3_f32 v160, v160, v88, v89
    v_max3_f32 v160, v160, v90, v91
    v_max3_f32 v160, v160, v92, v93
    v_max3_f32 v160, v160, v94, v95
    v_max3_f32 v176, v176, v112, v113
    v_max3_f32 v176, v176, v114, v115
    v_max3_f32 v176, v176, v116, v117
    v_max3_f32 v176, v176, v118, v119
    v_max3_f32 v176, v176, v120, v121
    v_max3_f32 v176, v176, v122, v123
    v_max3_f32 v176, v176, v124, v125
    v_max3_f32 v176, v176, v126, v127
    ds_read_b64_tr_b16 v[48:49], v1 offset:11968
    ds_read_b64_tr_b16 v[50:51], v1 offset:13248
    ds_read_b64_tr_b16 v[56:57], v2 offset:11968
    s_waitcnt lgkmcnt(6)
    v_mfma_f32_32x32x16_bf16 v[80:95], v[52:55], v[32:35], 0
    v_mfma_f32_32x32x16_bf16 v[80:95], v[60:63], v[40:43], v[80:95]
    v_mfma_f32_32x32x16_bf16 v[112:127], v[52:55], v[36:39], 0
    v_mfma_f32_32x32x16_bf16 v[112:127], v[60:63], v[44:47], v[112:127]
    s_nop 9
    v_max3_f32 v160, v160, v80, v81
    v_max3_f32 v160, v160, v82, v83
    v_max3_f32 v160, v160, v84, v85
    v_max3_f32 v160, v160, v86, v87
    v_max3_f32 v160, v160, v88, v89
    v_max3_f32 v160, v160, v90, v91
    v_max3_f32 v160, v160, v92, v93
    v_max3_f32 v160, v160, v94, v95
    v_max3_f32 v176, v176, v112, v113
    v_max3_f32 v176, v176, v114, v115
    v_max3_f32 v176, v176, v116, v117
    v_max3_f32 v176, v176, v118, v119
    v_max3_f32 v176, v176, v120, v121
    v_max3_f32 v176, v176, v122, v123
    v_max3_f32 v176, v176, v124, v125
    v_max3_f32 v176, v176, v126, v127
    ds_read_b64_tr_b16 v[52:53], v1 offset:12032
    ds_read_b64_tr_b16 v[54:55], v1 offset:13312
    ds_read_b64_tr_b16 v[60:61], v2 offset:12032
    s_waitcnt lgkmcnt(6)
    s_barrier
    s_waitcnt lgkmcnt(3)
    v_mfma_f32_32x32x16_bf16 v[80:95], v[48:51], v[32:35], 0
    v_mfma_f32_32x32x16_bf16 v[80:95], v[56:59], v[40:43], v[80:95]
    v_mfma_f32_32x32x16_bf16 v[112:127], v[48:51], v[36:39], 0
    v_mfma_f32_32x32x16_bf16 v[112:127], v[56:59], v[44:47], v[112:127]
    s_nop 9
    v_max3_f32 v160, v160, v80, v81
    v_max3_f32 v160, v160, v82, v83
    v_max3_f32 v160, v160, v84, v85
    v_max3_f32 v160, v160, v86, v87
    v_max3_f32 v160, v160, v88, v89
    v_max3_f32 v160, v160, v90, v91
    v_max3_f32 v160, v160, v92, v93
    v_max3_f32 v160, v160, v94, v95
    v_max3_f32 v176, v176, v112, v113
    v_max3_f32 v176, v176, v114, v115
    v_max3_f32 v176, v176, v116, v117
    v_max3_f32 v176, v176, v118, v119
    v_max3_f32 v176, v176, v120, v121
    v_max3_f32 v176, v176, v122, v123
    v_max3_f32 v176, v176, v124, v125
    v_max3_f32 v176, v176, v126, v127
    ds_read_b64_tr_b16 v[48:49], v1 offset:23680
    ds_read_b64_tr_b16 v[50:51], v1 offset:24960
    ds_read_b64_tr_b16 v[56:57], v2 offset:23680
    s_waitcnt lgkmcnt(3)
    v_mfma_f32_32x32x16_bf16 v[80:95], v[52:55], v[32:35], 0
    v_mfma_f32_32x32x16_bf16 v[80:95], v[60:63], v[40:43], v[80:95]
    v_mfma_f32_32x32x16_bf16 v[112:127], v[52:55], v[36:39], 0
    v_mfma_f32_32x32x16_bf16 v[112:127], v[60:63], v[44:47], v[112:127]
    s_nop 9
    v_max3_f32 v160, v160, v80, v81
    v_max3_f32 v160, v160, v82, v83
    v_max3_f32 v160, v160, v84, v85
    v_max3_f32 v160, v160, v86, v87
    v_max3_f32 v160, v160, v88, v89
    v_max3_f32 v160, v160, v90, v91
    v_max3_f32 v160, v160, v92, v93
    v_max3_f32 v160, v160, v94, v95
    v_max3_f32 v176, v176, v112, v113
    v_max3_f32 v176, v176, v114, v115
    v_max3_f32 v176, v176, v116, v117
    v_max3_f32 v176, v176, v118, v119
    v_max3_f32 v176, v176, v120, v121
    v_max3_f32 v176, v176, v122, v123
    v_max3_f32 v176, v176, v124, v125
    v_max3_f32 v176, v176, v126, v127
    ds_read_b64_tr_b16 v[52:53], v1 offset:23744
    ds_read_b64_tr_b16 v[54:55], v1 offset:25024
    ds_read_b64_tr_b16 v[60:61], v2 offset:23744
    s_waitcnt vmcnt(0)
    ds_write_b128 v7, v[20:23] offset:35520
    ds_write_b128 v8, v[24:27] offset:35520
    s_mov_b64 exec, s[34:35]
    ds_write_b128 v9, v[28:31] offset:35520
    s_mov_b64 exec, -1
    buffer_load_dwordx4 v[20:23], v4, s[4:7], s28 offen
    buffer_load_dwordx4 v[24:27], v5, s[4:7], s28 offen
    s_mov_b64 exec, s[34:35]
    buffer_load_dwordx4 v[28:31], v6, s[4:7], s28 offen
    s_mov_b64 exec, -1
    s_add_u32 s28, s28, 256
    s_waitcnt lgkmcnt(6)
    v_mfma_f32_32x32x16_bf16 v[80:95], v[48:51], v[32:35], 0
    v_mfma_f32_32x32x16_bf16 v[80:95], v[56:59], v[40:43], v[80:95]
    v_mfma_f32_32x32x16_bf16 v[112:127], v[48:51], v[36:39], 0
    v_mfma_f32_32x32x16_bf16 v[112:127], v[56:59], v[44:47], v[112:127]
    s_nop 9
    v_max3_f32 v160, v160, v80, v81
    v_max3_f32 v160, v160, v82, v83
    v_max3_f32 v160, v160, v84, v85
    v_max3_f32 v160, v160, v86, v87
    v_max3_f32 v160, v160, v88, v89
    v_max3_f32 v160, v160, v90, v91
    v_max3_f32 v160, v160, v92, v93
    v_max3_f32 v160, v160, v94, v95
    v_max3_f32 v176, v176, v112, v113
    v_max3_f32 v176, v176, v114, v115
    v_max3_f32 v176, v176, v116, v117
    v_max3_f32 v176, v176, v118, v119
    v_max3_f32 v176, v176, v120, v121
    v_max3_f32 v176, v176, v122, v123
    v_max3_f32 v176, v176, v124, v125
    v_max3_f32 v176, v176, v126, v127
    ds_read_b64_tr_b16 v[48:49], v1 offset:23808
    ds_read_b64_tr_b16 v[50:51], v1 offset:25088
    ds_read_b64_tr_b16 v[56:57], v2 offset:23808
    s_waitcnt lgkmcnt(6)
    v_mfma_f32_32x32x16_bf16 v[80:95], v[52:55], v[32:35], 0
    v_mfma_f32_32x32x16_bf16 v[80:95], v[60:63], v[40:43], v[80:95]
    v_mfma_f32_32x32x16_bf16 v[112:127], v[52:55], v[36:39], 0
    v_mfma_f32_32x32x16_bf16 v[112:127], v[60:63], v[44:47], v[112:127]
    s_nop 9
    v_max3_f32 v160, v160, v80, v81
    v_max3_f32 v160, v160, v82, v83
    v_max3_f32 v160, v160, v84, v85
    v_max3_f32 v160, v160, v86, v87
    v_max3_f32 v160, v160, v88, v89
    v_max3_f32 v160, v160, v90, v91
    v_max3_f32 v160, v160, v92, v93
    v_max3_f32 v160, v160, v94, v95
    v_max3_f32 v176, v176, v112, v113
    v_max3_f32 v176, v176, v114, v115
    v_max3_f32 v176, v176, v116, v117
    v_max3_f32 v176, v176, v118, v119
    v_max3_f32 v176, v176, v120, v121
    v_max3_f32 v176, v176, v122, v123
    v_max3_f32 v176, v176, v124, v125
    v_max3_f32 v176, v176, v126, v127
    ds_read_b64_tr_b16 v[52:53], v1 offset:23872
    ds_read_b64_tr_b16 v[54:55], v1 offset:25152
    ds_read_b64_tr_b16 v[60:61], v2 offset:23872
    s_waitcnt lgkmcnt(6)
    s_barrier
    s_waitcnt lgkmcnt(3)
    v_mfma_f32_32x32x16_bf16 v[80:95], v[48:51], v[32:35], 0
    v_mfma_f32_32x32x16_bf16 v[80:95], v[56:59], v[40:43], v[80:95]
    v_mfma_f32_32x32x16_bf16 v[112:127], v[48:51], v[36:39], 0
    v_mfma_f32_32x32x16_bf16 v[112:127], v[56:59], v[44:47], v[112:127]
    s_nop 9
    v_max3_f32 v160, v160, v80, v81
    v_max3_f32 v160, v160, v82, v83
    v_max3_f32 v160, v160, v84, v85
    v_max3_f32 v160, v160, v86, v87
    v_max3_f32 v160, v160, v88, v89
    v_max3_f32 v160, v160, v90, v91
    v_max3_f32 v160, v160, v92, v93
    v_max3_f32 v160, v160, v94, v95
    v_max3_f32 v176, v176, v112, v113
    v_max3_f32 v176, v176, v114, v115
    v_max3_f32 v176, v176, v116, v117
    v_max3_f32 v176, v176, v118, v119
    v_max3_f32 v176, v176, v120, v121
    v_max3_f32 v176, v176, v122, v123
    v_max3_f32 v176, v176, v124, v125
    v_max3_f32 v176, v176, v126, v127
    ds_read_b64_tr_b16 v[48:49], v1 offset:35520
    ds_read_b64_tr_b16 v[50:51], v1 offset:36800
    ds_read_b64_tr_b16 v[56:57], v2 offset:35520
    s_waitcnt lgkmcnt(3)
    v_mfma_f32_32x32x16_bf16 v[80:95], v[52:55], v[32:35], 0
    v_mfma_f32_32x32x16_bf16 v[80:95], v[60:63], v[40:43], v[80:95]
    v_mfma_f32_32x32x16_bf16 v[112:127], v[52:55], v[36:39], 0
    v_mfma_f32_32x32x16_bf16 v[112:127], v[60:63], v[44:47], v[112:127]
    s_nop 9
    v_max3_f32 v160, v160, v80, v81
    v_max3_f32 v160, v160, v82, v83
    v_max3_f32 v160, v160, v84, v85
    v_max3_f32 v160, v160, v86, v87
    v_max3_f32 v160, v160, v88, v89
    v_max3_f32 v160, v160, v90, v91
    v_max3_f32 v160, v160, v92, v93
    v_max3_f32 v160, v160, v94, v95
    v_max3_f32 v176, v176, v112, v113
    v_max3_f32 v176, v176, v114, v115
    v_max3_f32 v176, v176, v116, v117
    v_max3_f32 v176, v176, v118, v119
    v_max3_f32 v176, v176, v120, v121
    v_max3_f32 v176, v176, v122, v123
    v_max3_f32 v176, v176, v124, v125
    v_max3_f32 v176, v176, v126, v127
    ds_read_b64_tr_b16 v[52:53], v1 offset:35584
    ds_read_b64_tr_b16 v[54:55], v1 offset:36864
    ds_read_b64_tr_b16 v[60:61], v2 offset:35584
    s_waitcnt vmcnt(0)
    ds_write_b128 v7, v[20:23] offset:0
    ds_write_b128 v8, v[24:27] offset:0
    s_mov_b64 exec, s[34:35]
    ds_write_b128 v9, v[28:31] offset:0
    s_mov_b64 exec, -1
    buffer_load_dwordx4 v[20:23], v4, s[4:7], s28 offen
    buffer_load_dwordx4 v[24:27], v5, s[4:7], s28 offen
    s_mov_b64 exec, s[34:35]
    buffer_load_dwordx4 v[28:31], v6, s[4:7], s28 offen
    s_mov_b64 exec, -1
    s_add_u32 s28, s28, 256
    s_waitcnt lgkmcnt(6)
    v_mfma_f32_32x32x16_bf16 v[80:95], v[48:51], v[32:35], 0
    v_mfma_f32_32x32x16_bf16 v[80:95], v[56:59], v[40:43], v[80:95]
    v_mfma_f32_32x32x16_bf16 v[112:127], v[48:51], v[36:39], 0
    v_mfma_f32_32x32x16_bf16 v[112:127], v[56:59], v[44:47], v[112:127]
    s_nop 9
    v_max3_f32 v160, v160, v80, v81
    v_max3_f32 v160, v160, v82, v83
    v_max3_f32 v160, v160, v84, v85
    v_max3_f32 v160, v160, v86, v87
    v_max3_f32 v160, v160, v88, v89
    v_max3_f32 v160, v160, v90, v91
    v_max3_f32 v160, v160, v92, v93
    v_max3_f32 v160, v160, v94, v95
    v_max3_f32 v176, v176, v112, v113
    v_max3_f32 v176, v176, v114, v115
    v_max3_f32 v176, v176, v116, v117
    v_max3_f32 v176, v176, v118, v119
    v_max3_f32 v176, v176, v120, v121
    v_max3_f32 v176, v176, v122, v123
    v_max3_f32 v176, v176, v124, v125
    v_max3_f32 v176, v176, v126, v127
    ds_read_b64_tr_b16 v[48:49], v1 offset:35648
    ds_read_b64_tr_b16 v[50:51], v1 offset:36928
    ds_read_b64_tr_b16 v[56:57], v2 offset:35648
    s_waitcnt lgkmcnt(6)
    v_mfma_f32_32x32x16_bf16 v[80:95], v[52:55], v[32:35], 0
    v_mfma_f32_32x32x16_bf16 v[80:95], v[60:63], v[40:43], v[80:95]
    v_mfma_f32_32x32x16_bf16 v[112:127], v[52:55], v[36:39], 0
    v_mfma_f32_32x32x16_bf16 v[112:127], v[60:63], v[44:47], v[112:127]
    s_nop 9
    v_max3_f32 v160, v160, v80, v81
    v_max3_f32 v160, v160, v82, v83
    v_max3_f32 v160, v160, v84, v85
    v_max3_f32 v160, v160, v86, v87
    v_max3_f32 v160, v160, v88, v89
    v_max3_f32 v160, v160, v90, v91
    v_max3_f32 v160, v160, v92, v93
    v_max3_f32 v160, v160, v94, v95
    v_max3_f32 v176, v176, v112, v113
    v_max3_f32 v176, v176, v114, v115
    v_max3_f32 v176, v176, v116, v117
    v_max3_f32 v176, v176, v118, v119
    v_max3_f32 v176, v176, v120, v121
    v_max3_f32 v176, v176, v122, v123
    v_max3_f32 v176, v176, v124, v125
    v_max3_f32 v176, v176, v126, v127
    ds_read_b64_tr_b16 v[52:53], v1 offset:35712
    ds_read_b64_tr_b16 v[54:55], v1 offset:36992
    ds_read_b64_tr_b16 v[60:61], v2 offset:35712
    s_waitcnt lgkmcnt(6)
    s_barrier
    s_waitcnt lgkmcnt(3)
    v_mfma_f32_32x32x16_bf16 v[80:95], v[48:51], v[32:35], 0
    v_mfma_f32_32x32x16_bf16 v[80:95], v[56:59], v[40:43], v[80:95]
    v_mfma_f32_32x32x16_bf16 v[112:127], v[48:51], v[36:39], 0
    v_mfma_f32_32x32x16_bf16 v[112:127], v[56:59], v[44:47], v[112:127]
    s_nop 9
    v_max3_f32 v160, v160, v80, v81
    v_max3_f32 v160, v160, v82, v83
    v_max3_f32 v160, v160, v84, v85
    v_max3_f32 v160, v160, v86, v87
    v_max3_f32 v160, v160, v88, v89
    v_max3_f32 v160, v160, v90, v91
    v_max3_f32 v160, v160, v92, v93
    v_max3_f32 v160, v160, v94, v95
    v_max3_f32 v176, v176, v112, v113
    v_max3_f32 v176, v176, v114, v115
    v_max3_f32 v176, v176, v116, v117
    v_max3_f32 v176, v176, v118, v119
    v_max3_f32 v176, v176, v120, v121
    v_max3_f32 v176, v176, v122, v123
    v_max3_f32 v176, v176, v124, v125
    v_max3_f32 v176, v176, v126, v127
    ds_read_b64_tr_b16 v[48:49], v1 offset:0
    ds_read_b64_tr_b16 v[50:51], v1 offset:1280
    ds_read_b64_tr_b16 v[56:57], v2 offset:0
    s_waitcnt lgkmcnt(3)
    v_mfma_f32_32x32x16_bf16 v[80:95], v[52:55], v[32:35], 0
    v_mfma_f32_32x32x16_bf16 v[80:95], v[60:63], v[40:43], v[80:95]
    v_mfma_f32_32x32x16_bf16 v[112:127], v[52:55], v[36:39], 0
    v_mfma_f32_32x32x16_bf16 v[112:127], v[60:63], v[44:47], v[112:127]
    s_nop 9
    v_max3_f32 v160, v160, v80, v81
    v_max3_f32 v160, v160, v82, v83
    v_max3_f32 v160, v160, v84, v85
    v_max3_f32 v160, v160, v86, v87
    v_max3_f32 v160, v160, v88, v89
    v_max3_f32 v160, v160, v90, v91
    v_max3_f32 v160, v160, v92, v93
    v_max3_f32 v160, v160, v94, v95
    v_max3_f32 v176, v176, v112, v113
    v_max3_f32 v176, v176, v114, v115
    v_max3_f32 v176, v176, v116, v117
    v_max3_f32 v176, v176, v118, v119
    v_max3_f32 v176, v176, v120, v121
    v_max3_f32 v176, v176, v122, v123
    v_max3_f32 v176, v176, v124, v125
    v_max3_f32 v176, v176, v126, v127
    ds_read_b64_tr_b16 v[52:53], v1 offset:64
    ds_read_b64_tr_b16 v[54:55], v1 offset:1344
    ds_read_b64_tr_b16 v[60:61], v2 offset:64
    s_add_u32 s29, s29, 1
    s_cmp_lt_u32 s29, 4
    s_cbranch_scc1 AMAX_16
    s_waitcnt vmcnt(0) lgkmcnt(0)
    v_mov_b32 v10, v160
    v_mov_b32 v11, v160
    s_nop 1
    v_permlane32_swap_b32 v10, v11
    v_max_f32 v10, v10, v11
    v_cvt_pk_bf16_f32 v11, v10, v10
    v_lshlrev_b32 v11, 16, v11
    v_sub_f32 v12, v10, v11
    v_cvt_pk_bf16_f32 v12, -v11, -v12
    v_cndmask_b32 v41, 0, v12, s[32:33]
    v_mov_b32 v10, v176
    v_mov_b32 v11, v176
    s_nop 1
    v_permlane32_swap_b32 v10, v11
    v_max_f32 v10, v10, v11
    v_cvt_pk_bf16_f32 v11, v10, v10
    v_lshlrev_b32 v11, 16, v11
    v_sub_f32 v12, v10, v11
    v_cvt_pk_bf16_f32 v12, -v11, -v12
    v_cndmask_b32 v45, 0, v12, s[32:33]
    s_mov_b32 s36, 1
    s_barrier
    s_branch APASS2_11
    s_endpgm
CONV_9:
    s_cmp_ge_u32 s2, 400
    s_cbranch_scc1 GATE_17
    s_sub_u32 s3, s2, 256
    s_load_dwordx2 s[22:23], s[0:1], 72
    s_load_dwordx2 s[24:25], s[0:1], 104
    v_lshrrev_b32 v1, 6, v0
    s_nop 0
    v_readfirstlane_b32 s26, v1
    s_lshl_b32 s27, s3, 2
    s_add_u32 s27, s27, s26
    s_waitcnt lgkmcnt(0)
    s_add_u32 s4, s24, 0x1100000
    s_addc_u32 s5, s25, 0
    s_mov_b32 s6, 0x252000
    s_mov_b32 s7, 0x00020000
    s_add_u32 s8, s24, 0xc00000
    s_addc_u32 s9, s25, 0
    s_mov_b32 s10, 0x240000
    s_mov_b32 s11, 0x00020000
    s_add_u32 s12, s24, 0x1400000
    s_addc_u32 s13, s25, 0
    s_mov_b32 s14, 0x240000
    s_mov_b32 s15, 0x00020000
    s_lshr_b32 s28, s27, 1
    s_lshl_b32 s28, s28, 2
    s_load_dword s29, s[22:23], s28
    s_mul_i32 s30, s27, 4224
    s_lshl_b32 s31, s27, 12
    s_mul_i32 s32, s26, 15248
    v_and_b32 v2, 63, v0
    v_lshlrev_b32 v3, 4, v2
    v_and_b32 v5, 7, v2
    v_lshlrev_b32 v5, 4, v5
    v_lshrrev_b32 v4, 3, v2
    v_lshl_add_u32 v13, v4, 1, v5
    v_mul_u32_u24 v14, 1312, v4
    v_add3_u32 v14, v14, v5, s32
    buffer_load_dwordx4 v[16:19], v3, s[8:11], s31 offen offset:0
    buffer_load_dwordx4 v[20:23], v3, s[8:11], s31 offen offset:1024
    buffer_load_dwordx4 v[24:27], v3, s[8:11], s31 offen offset:2048
    buffer_load_dwordx4 v[28:31], v3, s[8:11], s31 offen offset:3072
    s_add_u32 s33, s30, 3072
    buffer_load_dwordx4 v[120:123], v13, s[4:7], s33 offen offset:0
    buffer_load_dwordx4 v[124:127], v13, s[4:7], s33 offen offset:128
    buffer_load_dwordx4 v[128:131], v13, s[4:7], s33 offen offset:256
    buffer_load_dwordx4 v[132:135], v13, s[4:7], s33 offen offset:384
    buffer_load_dwordx4 v[136:139], v13, s[4:7], s33 offen offset:512
    buffer_load_dwordx4 v[140:143], v13, s[4:7], s33 offen offset:640
    buffer_load_dwordx4 v[144:147], v13, s[4:7], s33 offen offset:768
    buffer_load_dwordx4 v[148:151], v13, s[4:7], s33 offen offset:896
    buffer_load_dwordx4 v[152:155], v13, s[4:7], s33 offen offset:1024
    v_cmp_gt_u32 vcc, 8, v2
    s_mov_b64 s[34:35], vcc
    v_mul_u32_u24 v4, 144, v4
    v_add3_u32 v4, v4, v5, s32
    v_mov_b32 v56, 0
    v_mov_b32 v57, 0
    v_mov_b32 v58, 0
    v_mov_b32 v59, 0
    s_mov_b64 exec, s[34:35]
    ds_write_b128 v4, v[56:59]
    s_mov_b64 exec, -1
    v_and_b32 v6, 31, v2
    v_bfe_u32 v7, v2, 5, 1
    v_and_b32 v8, 7, v6
    v_sub_u32 v8, 7, v8
    v_mul_u32_u24 v8, 1312, v8
    v_lshrrev_b32 v9, 3, v6
    v_sub_u32 v9, v7, v9
    v_lshl_add_u32 v8, v9, 4, v8
    v_add_u32 v8, s32, v8
    v_add_u32 v8, 4800, v8
    v_lshlrev_b32 v10, 4, v7
    v_add_u32 v10, s32, v10
    v_mul_u32_u24 v9, 144, v6
    v_add_u32 v9, v9, v10
    v_add_u32 v9, 144, v9
    s_waitcnt vmcnt(9)
    ds_write_b128 v4, v[16:19] offset:144
    ds_write_b128 v4, v[20:23] offset:1296
    ds_write_b128 v4, v[24:27] offset:2448
    ds_write_b128 v4, v[28:31] offset:3600
    s_waitcnt vmcnt(0)
    ds_write_b128 v14, v[120:123] offset:4752
    ds_write_b128 v14, v[124:127] offset:4880
    ds_write_b128 v14, v[128:131] offset:5008
    ds_write_b128 v14, v[132:135] offset:5136
    ds_write_b128 v14, v[136:139] offset:5264
    ds_write_b128 v14, v[140:143] offset:5392
    ds_write_b128 v14, v[144:147] offset:5520
    ds_write_b128 v14, v[148:151] offset:5648
    ds_write_b128 v14, v[152:155] offset:5776
    s_add_u32 s33, s30, 2048
    buffer_load_dwordx4 v[120:123], v13, s[4:7], s33 offen offset:0
    buffer_load_dwordx4 v[124:127], v13, s[4:7], s33 offen offset:128
    buffer_load_dwordx4 v[128:131], v13, s[4:7], s33 offen offset:256
    buffer_load_dwordx4 v[132:135], v13, s[4:7], s33 offen offset:384
    buffer_load_dwordx4 v[136:139], v13, s[4:7], s33 offen offset:512
    buffer_load_dwordx4 v[140:143], v13, s[4:7], s33 offen offset:640
    buffer_load_dwordx4 v[144:147], v13, s[4:7], s33 offen offset:768
    buffer_load_dwordx4 v[148:151], v13, s[4:7], s33 offen offset:896
    buffer_load_dwordx4 v[152:155], v13, s[4:7], s33 offen offset:1024
    s_waitcnt lgkmcnt(0)
    v_max_i32 v11, v9, v10
    ds_read_b128 v[44:47], v8 offset:1056
    ds_read_b128 v[48:51], v8 offset:1024
    ds_read_b128 v[52:55], v8 offset:992
    ds_read_b128 v[16:19], v8 offset:960
    ds_read_b128 v[20:23], v8 offset:928
    ds_read_b128 v[24:27], v8 offset:896
    ds_read_b128 v[56:59], v11 offset:0
    ds_read_b128 v[60:63], v11 offset:32
    ds_read_b128 v[64:67], v11 offset:64
    ds_read_b128 v[68:71], v11 offset:96
    v_subrev_u32 v9, 144, v9
    v_max_i32 v11, v9, v10
    ds_read_b128 v[28:31], v8 offset:864
    ds_read_b128 v[32:35], v8 offset:832
    ds_read_b128 v[36:39], v8 offset:800
    ds_read_b128 v[40:43], v8 offset:768
    ds_read_b128 v[72:75], v11 offset:0
    ds_read_b128 v[76:79], v11 offset:32
    ds_read_b128 v[80:83], v11 offset:64
    ds_read_b128 v[84:87], v11 offset:96
    s_waitcnt lgkmcnt(8)
    v_mfma_f32_32x32x16_bf16 v[88:103], v[16:19], v[56:59], 0
    v_mfma_f32_32x32x16_bf16 v[104:119], v[24:27], v[56:59], 0
    v_mfma_f32_32x32x16_bf16 v[88:103], v[52:55], v[60:63], v[88:103]
    v_mfma_f32_32x32x16_bf16 v[104:119], v[20:23], v[60:63], v[104:119]
    v_mfma_f32_32x32x16_bf16 v[88:103], v[48:51], v[64:67], v[88:103]
    v_mfma_f32_32x32x16_bf16 v[104:119], v[16:19], v[64:67], v[104:119]
    v_mfma_f32_32x32x16_bf16 v[88:103], v[44:47], v[68:71], v[88:103]
    v_mfma_f32_32x32x16_bf16 v[104:119], v[52:55], v[68:71], v[104:119]
    v_subrev_u32 v9, 144, v9
    v_max_i32 v11, v9, v10
    ds_read_b128 v[44:47], v8 offset:736
    ds_read_b128 v[48:51], v8 offset:704
    ds_read_b128 v[52:55], v8 offset:672
    ds_read_b128 v[16:19], v8 offset:640
    ds_read_b128 v[56:59], v11 offset:0
    ds_read_b128 v[60:63], v11 offset:32
    ds_read_b128 v[64:67], v11 offset:64
    ds_read_b128 v[68:71], v11 offset:96
    s_waitcnt lgkmcnt(8)
    v_mfma_f32_32x32x16_bf16 v[88:103], v[32:35], v[72:75], v[88:103]
    v_mfma_f32_32x32x16_bf16 v[104:119], v[40:43], v[72:75], v[104:119]
    v_mfma_f32_32x32x16_bf16 v[88:103], v[28:31], v[76:79], v[88:103]
    v_mfma_f32_32x32x16_bf16 v[104:119], v[36:39], v[76:79], v[104:119]
    v_mfma_f32_32x32x16_bf16 v[88:103], v[24:27], v[80:83], v[88:103]
    v_mfma_f32_32x32x16_bf16 v[104:119], v[32:35], v[80:83], v[104:119]
    v_mfma_f32_32x32x16_bf16 v[88:103], v[20:23], v[84:87], v[88:103]
    v_mfma_f32_32x32x16_bf16 v[104:119], v[28:31], v[84:87], v[104:119]
    v_subrev_u32 v9, 144, v9
    v_max_i32 v11, v9, v10
    ds_read_b128 v[20:23], v8 offset:608
    ds_read_b128 v[24:27], v8 offset:576
    ds_read_b128 v[28:31], v8 offset:544
    ds_read_b128 v[32:35], v8 offset:512
    ds_read_b128 v[72:75], v11 offset:0
    ds_read_b128 v[76:79], v11 offset:32
    ds_read_b128 v[80:83], v11 offset:64
    ds_read_b128 v[84:87], v11 offset:96
    s_waitcnt lgkmcnt(8)
    v_mfma_f32_32x32x16_bf16 v[88:103], v[48:51], v[56:59], v[88:103]
    v_mfma_f32_32x32x16_bf16 v[104:119], v[16:19], v[56:59], v[104:119]
    v_mfma_f32_32x32x16_bf16 v[88:103], v[44:47], v[60:63], v[88:103]
    v_mfma_f32_32x32x16_bf16 v[104:119], v[52:55], v[60:63], v[104:119]
    v_mfma_f32_32x32x16_bf16 v[88:103], v[40:43], v[64:67], v[88:103]
    v_mfma_f32_32x32x16_bf16 v[104:119], v[48:51], v[64:67], v[104:119]
    v_mfma_f32_32x32x16_bf16 v[88:103], v[36:39], v[68:71], v[88:103]
    v_mfma_f32_32x32x16_bf16 v[104:119], v[44:47], v[68:71], v[104:119]
    v_subrev_u32 v9, 144, v9
    v_max_i32 v11, v9, v10
    ds_read_b128 v[36:39], v8 offset:480
    ds_read_b128 v[40:43], v8 offset:448
    ds_read_b128 v[44:47], v8 offset:416
    ds_read_b128 v[48:51], v8 offset:384
    ds_read_b128 v[56:59], v11 offset:0
    ds_read_b128 v[60:63], v11 offset:32
    ds_read_b128 v[64:67], v11 offset:64
    ds_read_b128 v[68:71], v11 offset:96
    s_waitcnt lgkmcnt(8)
    v_mfma_f32_32x32x16_bf16 v[88:103], v[24:27], v[72:75], v[88:103]
    v_mfma_f32_32x32x16_bf16 v[104:119], v[32:35], v[72:75], v[104:119]
    v_mfma_f32_32x32x16_bf16 v[88:103], v[20:23], v[76:79], v[88:103]
    v_mfma_f32_32x32x16_bf16 v[104:119], v[28:31], v[76:79], v[104:119]
    v_mfma_f32_32x32x16_bf16 v[88:103], v[16:19], v[80:83], v[88:103]
    v_mfma_f32_32x32x16_bf16 v[104:119], v[24:27], v[80:83], v[104:119]
    v_mfma_f32_32x32x16_bf16 v[88:103], v[52:55], v[84:87], v[88:103]
    v_mfma_f32_32x32x16_bf16 v[104:119], v[20:23], v[84:87], v[104:119]
    v_subrev_u32 v9, 144, v9
    v_max_i32 v11, v9, v10
    ds_read_b128 v[52:55], v8 offset:352
    ds_read_b128 v[16:19], v8 offset:320
    ds_read_b128 v[20:23], v8 offset:288
    ds_read_b128 v[24:27], v8 offset:256
    ds_read_b128 v[72:75], v11 offset:0
    ds_read_b128 v[76:79], v11 offset:32
    ds_read_b128 v[80:83], v11 offset:64
    ds_read_b128 v[84:87], v11 offset:96
    s_waitcnt lgkmcnt(8)
    v_mfma_f32_32x32x16_bf16 v[88:103], v[40:43], v[56:59], v[88:103]
    v_mfma_f32_32x32x16_bf16 v[104:119], v[48:51], v[56:59], v[104:119]
    v_mfma_f32_32x32x16_bf16 v[88:103], v[36:39], v[60:63], v[88:103]
    v_mfma_f32_32x32x16_bf16 v[104:119], v[44:47], v[60:63], v[104:119]
    v_mfma_f32_32x32x16_bf16 v[88:103], v[32:35], v[64:67], v[88:103]
    v_mfma_f32_32x32x16_bf16 v[104:119], v[40:43], v[64:67], v[104:119]
    v_mfma_f32_32x32x16_bf16 v[88:103], v[28:31], v[68:71], v[88:103]
    v_mfma_f32_32x32x16_bf16 v[104:119], v[36:39], v[68:71], v[104:119]
    v_subrev_u32 v9, 144, v9
    v_max_i32 v11, v9, v10
    ds_read_b128 v[28:31], v8 offset:224
    ds_read_b128 v[32:35], v8 offset:192
    ds_read_b128 v[36:39], v8 offset:160
    ds_read_b128 v[40:43], v8 offset:128
    ds_read_b128 v[56:59], v11 offset:0
    ds_read_b128 v[60:63], v11 offset:32
    ds_read_b128 v[64:67], v11 offset:64
    ds_read_b128 v[68:71], v11 offset:96
    s_waitcnt lgkmcnt(8)
    v_mfma_f32_32x32x16_bf16 v[88:103], v[16:19], v[72:75], v[88:103]
    v_mfma_f32_32x32x16_bf16 v[104:119], v[24:27], v[72:75], v[104:119]
    v_mfma_f32_32x32x16_bf16 v[88:103], v[52:55], v[76:79], v[88:103]
    v_mfma_f32_32x32x16_bf16 v[104:119], v[20:23], v[76:79], v[104:119]
    v_mfma_f32_32x32x16_bf16 v[88:103], v[48:51], v[80:83], v[88:103]
    v_mfma_f32_32x32x16_bf16 v[104:119], v[16:19], v[80:83], v[104:119]
    v_mfma_f32_32x32x16_bf16 v[88:103], v[44:47], v[84:87], v[88:103]
    v_mfma_f32_32x32x16_bf16 v[104:119], v[52:55], v[84:87], v[104:119]
    v_subrev_u32 v9, 144, v9
    v_max_i32 v11, v9, v10
    ds_read_b128 v[44:47], v8 offset:96
    ds_read_b128 v[48:51], v8 offset:64
    ds_read_b128 v[52:55], v8 offset:32
    ds_read_b128 v[16:19], v8 offset:0
    ds_read_b128 v[72:75], v11 offset:0
    ds_read_b128 v[76:79], v11 offset:32
    ds_read_b128 v[80:83], v11 offset:64
    ds_read_b128 v[84:87], v11 offset:96
    s_waitcnt lgkmcnt(8)
    v_mfma_f32_32x32x16_bf16 v[88:103], v[32:35], v[56:59], v[88:103]
    v_mfma_f32_32x32x16_bf16 v[104:119], v[40:43], v[56:59], v[104:119]
    v_mfma_f32_32x32x16_bf16 v[88:103], v[28:31], v[60:63], v[88:103]
    v_mfma_f32_32x32x16_bf16 v[104:119], v[36:39], v[60:63], v[104:119]
    v_mfma_f32_32x32x16_bf16 v[88:103], v[24:27], v[64:67], v[88:103]
    v_mfma_f32_32x32x16_bf16 v[104:119], v[32:35], v[64:67], v[104:119]
    v_mfma_f32_32x32x16_bf16 v[88:103], v[20:23], v[68:71], v[88:103]
    v_mfma_f32_32x32x16_bf16 v[104:119], v[28:31], v[68:71], v[104:119]
    v_subrev_u32 v9, 144, v9
    v_max_i32 v11, v9, v10
    s_waitcnt vmcnt(0)
    ds_write_b128 v14, v[120:123] offset:4752
    ds_write_b128 v14, v[124:127] offset:4880
    ds_write_b128 v14, v[128:131] offset:5008
    ds_write_b128 v14, v[132:135] offset:5136
    ds_write_b128 v14, v[136:139] offset:5264
    ds_write_b128 v14, v[140:143] offset:5392
    ds_write_b128 v14, v[144:147] offset:5520
    ds_write_b128 v14, v[148:151] offset:5648
    ds_write_b128 v14, v[152:155] offset:5776
    s_add_u32 s33, s30, 1024
    buffer_load_dwordx4 v[120:123], v13, s[4:7], s33 offen offset:0
    buffer_load_dwordx4 v[124:127], v13, s[4:7], s33 offen offset:128
    buffer_load_dwordx4 v[128:131], v13, s[4:7], s33 offen offset:256
    buffer_load_dwordx4 v[132:135], v13, s[4:7], s33 offen offset:384
    buffer_load_dwordx4 v[136:139], v13, s[4:7], s33 offen offset:512
    buffer_load_dwordx4 v[140:143], v13, s[4:7], s33 offen offset:640
    buffer_load_dwordx4 v[144:147], v13, s[4:7], s33 offen offset:768
    buffer_load_dwordx4 v[148:151], v13, s[4:7], s33 offen offset:896
    buffer_load_dwordx4 v[152:155], v13, s[4:7], s33 offen offset:1024
    ds_read_b128 v[20:23], v8 offset:992
    ds_read_b128 v[24:27], v8 offset:960
    ds_read_b128 v[28:31], v8 offset:928
    ds_read_b128 v[32:35], v8 offset:896
    ds_read_b128 v[56:59], v11 offset:0
    ds_read_b128 v[60:63], v11 offset:32
    ds_read_b128 v[64:67], v11 offset:64
    ds_read_b128 v[68:71], v11 offset:96
    s_waitcnt lgkmcnt(15)
    s_waitcnt lgkmcnt(8)
    v_mfma_f32_32x32x16_bf16 v[88:103], v[48:51], v[72:75], v[88:103]
    v_mfma_f32_32x32x16_bf16 v[104:119], v[16:19], v[72:75], v[104:119]
    v_mfma_f32_32x32x16_bf16 v[88:103], v[44:47], v[76:79], v[88:103]
    v_mfma_f32_32x32x16_bf16 v[104:119], v[52:55], v[76:79], v[104:119]
    v_mfma_f32_32x32x16_bf16 v[88:103], v[40:43], v[80:83], v[88:103]
    v_mfma_f32_32x32x16_bf16 v[104:119], v[48:51], v[80:83], v[104:119]
    v_mfma_f32_32x32x16_bf16 v[88:103], v[36:39], v[84:87], v[88:103]
    v_mfma_f32_32x32x16_bf16 v[104:119], v[44:47], v[84:87], v[104:119]
    v_subrev_u32 v9, 144, v9
    v_max_i32 v11, v9, v10
    ds_read_b128 v[36:39], v8 offset:864
    ds_read_b128 v[40:43], v8 offset:832
    ds_read_b128 v[44:47], v8 offset:800
    ds_read_b128 v[48:51], v8 offset:768
    ds_read_b128 v[72:75], v11 offset:0
    ds_read_b128 v[76:79], v11 offset:32
    ds_read_b128 v[80:83], v11 offset:64
    ds_read_b128 v[84:87], v11 offset:96
    s_waitcnt lgkmcnt(8)
    v_mfma_f32_32x32x16_bf16 v[88:103], v[24:27], v[56:59], v[88:103]
    v_mfma_f32_32x32x16_bf16 v[104:119], v[32:35], v[56:59], v[104:119]
    v_mfma_f32_32x32x16_bf16 v[88:103], v[20:23], v[60:63], v[88:103]
    v_mfma_f32_32x32x16_bf16 v[104:119], v[28:31], v[60:63], v[104:119]
    v_mfma_f32_32x32x16_bf16 v[88:103], v[16:19], v[64:67], v[88:103]
    v_mfma_f32_32x32x16_bf16 v[104:119], v[24:27], v[64:67], v[104:119]
    v_mfma_f32_32x32x16_bf16 v[88:103], v[52:55], v[68:71], v[88:103]
    v_mfma_f32_32x32x16_bf16 v[104:119], v[20:23], v[68:71], v[104:119]
    v_subrev_u32 v9, 144, v9
    v_max_i32 v11, v9, v10
    ds_read_b128 v[52:55], v8 offset:736
    ds_read_b128 v[16:19], v8 offset:704
    ds_read_b128 v[20:23], v8 offset:672
    ds_read_b128 v[24:27], v8 offset:640
    ds_read_b128 v[56:59], v11 offset:0
    ds_read_b128 v[60:63], v11 offset:32
    ds_read_b128 v[64:67], v11 offset:64
    ds_read_b128 v[68:71], v11 offset:96
    s_waitcnt lgkmcnt(8)
    v_mfma_f32_32x32x16_bf16 v[88:103], v[40:43], v[72:75], v[88:103]
    v_mfma_f32_32x32x16_bf16 v[104:119], v[48:51], v[72:75], v[104:119]
    v_mfma_f32_32x32x16_bf16 v[88:103], v[36:39], v[76:79], v[88:103]
    v_mfma_f32_32x32x16_bf16 v[104:119], v[44:47], v[76:79], v[104:119]
    v_mfma_f32_32x32x16_bf16 v[88:103], v[32:35], v[80:83], v[88:103]
    v_mfma_f32_32x32x16_bf16 v[104:119], v[40:43], v[80:83], v[104:119]
    v_mfma_f32_32x32x16_bf16 v[88:103], v[28:31], v[84:87], v[88:103]
    v_mfma_f32_32x32x16_bf16 v[104:119], v[36:39], v[84:87], v[104:119]
    v_subrev_u32 v9, 144, v9
    v_max_i32 v11, v9, v10
    ds_read_b128 v[28:31], v8 offset:608
    ds_read_b128 v[32:35], v8 offset:576
    ds_read_b128 v[36:39], v8 offset:544
    ds_read_b128 v[40:43], v8 offset:512
    ds_read_b128 v[72:75], v11 offset:0
    ds_read_b128 v[76:79], v11 offset:32
    ds_read_b128 v[80:83], v11 offset:64
    ds_read_b128 v[84:87], v11 offset:96
    s_waitcnt lgkmcnt(8)
    v_mfma_f32_32x32x16_bf16 v[88:103], v[16:19], v[56:59], v[88:103]
    v_mfma_f32_32x32x16_bf16 v[104:119], v[24:27], v[56:59], v[104:119]
    v_mfma_f32_32x32x16_bf16 v[88:103], v[52:55], v[60:63], v[88:103]
    v_mfma_f32_32x32x16_bf16 v[104:119], v[20:23], v[60:63], v[104:119]
    v_mfma_f32_32x32x16_bf16 v[88:103], v[48:51], v[64:67], v[88:103]
    v_mfma_f32_32x32x16_bf16 v[104:119], v[16:19], v[64:67], v[104:119]
    v_mfma_f32_32x32x16_bf16 v[88:103], v[44:47], v[68:71], v[88:103]
    v_mfma_f32_32x32x16_bf16 v[104:119], v[52:55], v[68:71], v[104:119]
    v_subrev_u32 v9, 144, v9
    v_max_i32 v11, v9, v10
    ds_read_b128 v[44:47], v8 offset:480
    ds_read_b128 v[48:51], v8 offset:448
    ds_read_b128 v[52:55], v8 offset:416
    ds_read_b128 v[16:19], v8 offset:384
    ds_read_b128 v[56:59], v11 offset:0
    ds_read_b128 v[60:63], v11 offset:32
    ds_read_b128 v[64:67], v11 offset:64
    ds_read_b128 v[68:71], v11 offset:96
    s_waitcnt lgkmcnt(8)
    v_mfma_f32_32x32x16_bf16 v[88:103], v[32:35], v[72:75], v[88:103]
    v_mfma_f32_32x32x16_bf16 v[104:119], v[40:43], v[72:75], v[104:119]
    v_mfma_f32_32x32x16_bf16 v[88:103], v[28:31], v[76:79], v[88:103]
    v_mfma_f32_32x32x16_bf16 v[104:119], v[36:39], v[76:79], v[104:119]
    v_mfma_f32_32x32x16_bf16 v[88:103], v[24:27], v[80:83], v[88:103]
    v_mfma_f32_32x32x16_bf16 v[104:119], v[32:35], v[80:83], v[104:119]
    v_mfma_f32_32x32x16_bf16 v[88:103], v[20:23], v[84:87], v[88:103]
    v_mfma_f32_32x32x16_bf16 v[104:119], v[28:31], v[84:87], v[104:119]
    v_subrev_u32 v9, 144, v9
    v_max_i32 v11, v9, v10
    ds_read_b128 v[20:23], v8 offset:352
    ds_read_b128 v[24:27], v8 offset:320
    ds_read_b128 v[28:31], v8 offset:288
    ds_read_b128 v[32:35], v8 offset:256
    ds_read_b128 v[72:75], v11 offset:0
    ds_read_b128 v[76:79], v11 offset:32
    ds_read_b128 v[80:83], v11 offset:64
    ds_read_b128 v[84:87], v11 offset:96
    s_waitcnt lgkmcnt(8)
    v_mfma_f32_32x32x16_bf16 v[88:103], v[48:51], v[56:59], v[88:103]
    v_mfma_f32_32x32x16_bf16 v[104:119], v[16:19], v[56:59], v[104:119]
    v_mfma_f32_32x32x16_bf16 v[88:103], v[44:47], v[60:63], v[88:103]
    v_mfma_f32_32x32x16_bf16 v[104:119], v[52:55], v[60:63], v[104:119]
    v_mfma_f32_32x32x16_bf16 v[88:103], v[40:43], v[64:67], v[88:103]
    v_mfma_f32_32x32x16_bf16 v[104:119], v[48:51], v[64:67], v[104:119]
    v_mfma_f32_32x32x16_bf16 v[88:103], v[36:39], v[68:71], v[88:103]
    v_mfma_f32_32x32x16_bf16 v[104:119], v[44:47], v[68:71], v[104:119]
    v_subrev_u32 v9, 144, v9
    v_max_i32 v11, v9, v10
    ds_read_b128 v[36:39], v8 offset:224
    ds_read_b128 v[40:43], v8 offset:192
    ds_read_b128 v[44:47], v8 offset:160
    ds_read_b128 v[48:51], v8 offset:128
    ds_read_b128 v[56:59], v11 offset:0
    ds_read_b128 v[60:63], v11 offset:32
    ds_read_b128 v[64:67], v11 offset:64
    ds_read_b128 v[68:71], v11 offset:96
    s_waitcnt lgkmcnt(8)
    v_mfma_f32_32x32x16_bf16 v[88:103], v[24:27], v[72:75], v[88:103]
    v_mfma_f32_32x32x16_bf16 v[104:119], v[32:35], v[72:75], v[104:119]
    v_mfma_f32_32x32x16_bf16 v[88:103], v[20:23], v[76:79], v[88:103]
    v_mfma_f32_32x32x16_bf16 v[104:119], v[28:31], v[76:79], v[104:119]
    v_mfma_f32_32x32x16_bf16 v[88:103], v[16:19], v[80:83], v[88:103]
    v_mfma_f32_32x32x16_bf16 v[104:119], v[24:27], v[80:83], v[104:119]
    v_mfma_f32_32x32x16_bf16 v[88:103], v[52:55], v[84:87], v[88:103]
    v_mfma_f32_32x32x16_bf16 v[104:119], v[20:23], v[84:87], v[104:119]
    v_subrev_u32 v9, 144, v9
    v_max_i32 v11, v9, v10
    ds_read_b128 v[52:55], v8 offset:96
    ds_read_b128 v[16:19], v8 offset:64
    ds_read_b128 v[20:23], v8 offset:32
    ds_read_b128 v[24:27], v8 offset:0
    ds_read_b128 v[72:75], v11 offset:0
    ds_read_b128 v[76:79], v11 offset:32
    ds_read_b128 v[80:83], v11 offset:64
    ds_read_b128 v[84:87], v11 offset:96
    s_waitcnt lgkmcnt(8)
    v_mfma_f32_32x32x16_bf16 v[88:103], v[40:43], v[56:59], v[88:103]
    v_mfma_f32_32x32x16_bf16 v[104:119], v[48:51], v[56:59], v[104:119]
    v_mfma_f32_32x32x16_bf16 v[88:103], v[36:39], v[60:63], v[88:103]
    v_mfma_f32_32x32x16_bf16 v[104:119], v[44:47], v[60:63], v[104:119]
    v_mfma_f32_32x32x16_bf16 v[88:103], v[32:35], v[64:67], v[88:103]
    v_mfma_f32_32x32x16_bf16 v[104:119], v[40:43], v[64:67], v[104:119]
    v_mfma_f32_32x32x16_bf16 v[88:103], v[28:31], v[68:71], v[88:103]
    v_mfma_f32_32x32x16_bf16 v[104:119], v[36:39], v[68:71], v[104:119]
    v_subrev_u32 v9, 144, v9
    v_max_i32 v11, v9, v10
    s_waitcnt vmcnt(0)
    ds_write_b128 v14, v[120:123] offset:4752
    ds_write_b128 v14, v[124:127] offset:4880
    ds_write_b128 v14, v[128:131] offset:5008
    ds_write_b128 v14, v[132:135] offset:5136
    ds_write_b128 v14, v[136:139] offset:5264
    ds_write_b128 v14, v[140:143] offset:5392
    ds_write_b128 v14, v[144:147] offset:5520
    ds_write_b128 v14, v[148:151] offset:5648
    ds_write_b128 v14, v[152:155] offset:5776
    s_add_u32 s33, s30, 0
    buffer_load_dwordx4 v[120:123], v13, s[4:7], s33 offen offset:0
    buffer_load_dwordx4 v[124:127], v13, s[4:7], s33 offen offset:128
    buffer_load_dwordx4 v[128:131], v13, s[4:7], s33 offen offset:256
    buffer_load_dwordx4 v[132:135], v13, s[4:7], s33 offen offset:384
    buffer_load_dwordx4 v[136:139], v13, s[4:7], s33 offen offset:512
    buffer_load_dwordx4 v[140:143], v13, s[4:7], s33 offen offset:640
    buffer_load_dwordx4 v[144:147], v13, s[4:7], s33 offen offset:768
    buffer_load_dwordx4 v[148:151], v13, s[4:7], s33 offen offset:896
    buffer_load_dwordx4 v[152:155], v13, s[4:7], s33 offen offset:1024
    ds_read_b128 v[28:31], v8 offset:992
    ds_read_b128 v[32:35], v8 offset:960
    ds_read_b128 v[36:39], v8 offset:928
    ds_read_b128 v[40:43], v8 offset:896
    ds_read_b128 v[56:59], v11 offset:0
    ds_read_b128 v[60:63], v11 offset:32
    ds_read_b128 v[64:67], v11 offset:64
    ds_read_b128 v[68:71], v11 offset:96
    s_waitcnt lgkmcnt(15)
    s_waitcnt lgkmcnt(8)
    v_mfma_f32_32x32x16_bf16 v[88:103], v[16:19], v[72:75], v[88:103]
    v_mfma_f32_32x32x16_bf16 v[104:119], v[24:27], v[72:75], v[104:119]
    v_mfma_f32_32x32x16_bf16 v[88:103], v[52:55], v[76:79], v[88:103]
    v_mfma_f32_32x32x16_bf16 v[104:119], v[20:23], v[76:79], v[104:119]
    v_mfma_f32_32x32x16_bf16 v[88:103], v[48:51], v[80:83], v[88:103]
    v_mfma_f32_32x32x16_bf16 v[104:119], v[16:19], v[80:83], v[104:119]
    v_mfma_f32_32x32x16_bf16 v[88:103], v[44:47], v[84:87], v[88:103]
    v_mfma_f32_32x32x16_bf16 v[104:119], v[52:55], v[84:87], v[104:119]
    v_subrev_u32 v9, 144, v9
    v_max_i32 v11, v9, v10
    ds_read_b128 v[44:47], v8 offset:864
    ds_read_b128 v[48:51], v8 offset:832
    ds_read_b128 v[52:55], v8 offset:800
    ds_read_b128 v[16:19], v8 offset:768
    ds_read_b128 v[72:75], v11 offset:0
    ds_read_b128 v[76:79], v11 offset:32
    ds_read_b128 v[80:83], v11 offset:64
    ds_read_b128 v[84:87], v11 offset:96
    s_waitcnt lgkmcnt(8)
    v_mfma_f32_32x32x16_bf16 v[88:103], v[32:35], v[56:59], v[88:103]
    v_mfma_f32_32x32x16_bf16 v[104:119], v[40:43], v[56:59], v[104:119]
    v_mfma_f32_32x32x16_bf16 v[88:103], v[28:31], v[60:63], v[88:103]
    v_mfma_f32_32x32x16_bf16 v[104:119], v[36:39], v[60:63], v[104:119]
    v_mfma_f32_32x32x16_bf16 v[88:103], v[24:27], v[64:67], v[88:103]
    v_mfma_f32_32x32x16_bf16 v[104:119], v[32:35], v[64:67], v[104:119]
    v_mfma_f32_32x32x16_bf16 v[88:103], v[20:23], v[68:71], v[88:103]
    v_mfma_f32_32x32x16_bf16 v[104:119], v[28:31], v[68:71], v[104:119]
    v_subrev_u32 v9, 144, v9
    v_max_i32 v11, v9, v10
    ds_read_b128 v[20:23], v8 offset:736
    ds_read_b128 v[24:27], v8 offset:704
    ds_read_b128 v[28:31], v8 offset:672
    ds_read_b128 v[32:35], v8 offset:640
    ds_read_b128 v[56:59], v11 offset:0
    ds_read_b128 v[60:63], v11 offset:32
    ds_read_b128 v[64:67], v11 offset:64
    ds_read_b128 v[68:71], v11 offset:96
    s_waitcnt lgkmcnt(8)
    v_mfma_f32_32x32x16_bf16 v[88:103], v[48:51], v[72:75], v[88:103]
    v_mfma_f32_32x32x16_bf16 v[104:119], v[16:19], v[72:75], v[104:119]
    v_mfma_f32_32x32x16_bf16 v[88:103], v[44:47], v[76:79], v[88:103]
    v_mfma_f32_32x32x16_bf16 v[104:119], v[52:55], v[76:79], v[104:119]
    v_mfma_f32_32x32x16_bf16 v[88:103], v[40:43], v[80:83], v[88:103]
    v_mfma_f32_32x32x16_bf16 v[104:119], v[48:51], v[80:83], v[104:119]
    v_mfma_f32_32x32x16_bf16 v[88:103], v[36:39], v[84:87], v[88:103]
    v_mfma_f32_32x32x16_bf16 v[104:119], v[44:47], v[84:87], v[104:119]
    v_subrev_u32 v9, 144, v9
    v_max_i32 v11, v9, v10
    ds_read_b128 v[36:39], v8 offset:608
    ds_read_b128 v[40:43], v8 offset:576
    ds_read_b128 v[44:47], v8 offset:544
    ds_read_b128 v[48:51], v8 offset:512
    ds_read_b128 v[72:75], v11 offset:0
    ds_read_b128 v[76:79], v11 offset:32
    ds_read_b128 v[80:83], v11 offset:64
    ds_read_b128 v[84:87], v11 offset:96
    s_waitcnt lgkmcnt(8)
    v_mfma_f32_32x32x16_bf16 v[88:103], v[24:27], v[56:59], v[88:103]
    v_mfma_f32_32x32x16_bf16 v[104:119], v[32:35], v[56:59], v[104:119]
    v_mfma_f32_32x32x16_bf16 v[88:103], v[20:23], v[60:63], v[88:103]
    v_mfma_f32_32x32x16_bf16 v[104:119], v[28:31], v[60:63], v[104:119]
    v_mfma_f32_32x32x16_bf16 v[88:103], v[16:19], v[64:67], v[88:103]
    v_mfma_f32_32x32x16_bf16 v[104:119], v[24:27], v[64:67], v[104:119]
    v_mfma_f32_32x32x16_bf16 v[88:103], v[52:55], v[68:71], v[88:103]
    v_mfma_f32_32x32x16_bf16 v[104:119], v[20:23], v[68:71], v[104:119]
    v_subrev_u32 v9, 144, v9
    v_max_i32 v11, v9, v10
    ds_read_b128 v[52:55], v8 offset:480
    ds_read_b128 v[16:19], v8 offset:448
    ds_read_b128 v[20:23], v8 offset:416
    ds_read_b128 v[24:27], v8 offset:384
    ds_read_b128 v[56:59], v11 offset:0
    ds_read_b128 v[60:63], v11 offset:32
    ds_read_b128 v[64:67], v11 offset:64
    ds_read_b128 v[68:71], v11 offset:96
    s_waitcnt lgkmcnt(8)
    v_mfma_f32_32x32x16_bf16 v[88:103], v[40:43], v[72:75], v[88:103]
    v_mfma_f32_32x32x16_bf16 v[104:119], v[48:51], v[72:75], v[104:119]
    v_mfma_f32_32x32x16_bf16 v[88:103], v[36:39], v[76:79], v[88:103]
    v_mfma_f32_32x32x16_bf16 v[104:119], v[44:47], v[76:79], v[104:119]
    v_mfma_f32_32x32x16_bf16 v[88:103], v[32:35], v[80:83], v[88:103]
    v_mfma_f32_32x32x16_bf16 v[104:119], v[40:43], v[80:83], v[104:119]
    v_mfma_f32_32x32x16_bf16 v[88:103], v[28:31], v[84:87], v[88:103]
    v_mfma_f32_32x32x16_bf16 v[104:119], v[36:39], v[84:87], v[104:119]
    v_subrev_u32 v9, 144, v9
    v_max_i32 v11, v9, v10
    ds_read_b128 v[28:31], v8 offset:352
    ds_read_b128 v[32:35], v8 offset:320
    ds_read_b128 v[36:39], v8 offset:288
    ds_read_b128 v[40:43], v8 offset:256
    ds_read_b128 v[72:75], v11 offset:0
    ds_read_b128 v[76:79], v11 offset:32
    ds_read_b128 v[80:83], v11 offset:64
    ds_read_b128 v[84:87], v11 offset:96
    s_waitcnt lgkmcnt(8)
    v_mfma_f32_32x32x16_bf16 v[88:103], v[16:19], v[56:59], v[88:103]
    v_mfma_f32_32x32x16_bf16 v[104:119], v[24:27], v[56:59], v[104:119]
    v_mfma_f32_32x32x16_bf16 v[88:103], v[52:55], v[60:63], v[88:103]
    v_mfma_f32_32x32x16_bf16 v[104:119], v[20:23], v[60:63], v[104:119]
    v_mfma_f32_32x32x16_bf16 v[88:103], v[48:51], v[64:67], v[88:103]
    v_mfma_f32_32x32x16_bf16 v[104:119], v[16:19], v[64:67], v[104:119]
    v_mfma_f32_32x32x16_bf16 v[88:103], v[44:47], v[68:71], v[88:103]
    v_mfma_f32_32x32x16_bf16 v[104:119], v[52:55], v[68:71], v[104:119]
    v_subrev_u32 v9, 144, v9
    v_max_i32 v11, v9, v10
    ds_read_b128 v[44:47], v8 offset:224
    ds_read_b128 v[48:51], v8 offset:192
    ds_read_b128 v[52:55], v8 offset:160
    ds_read_b128 v[16:19], v8 offset:128
    ds_read_b128 v[56:59], v11 offset:0
    ds_read_b128 v[60:63], v11 offset:32
    ds_read_b128 v[64:67], v11 offset:64
    ds_read_b128 v[68:71], v11 offset:96
    s_waitcnt lgkmcnt(8)
    v_mfma_f32_32x32x16_bf16 v[88:103], v[32:35], v[72:75], v[88:103]
    v_mfma_f32_32x32x16_bf16 v[104:119], v[40:43], v[72:75], v[104:119]
    v_mfma_f32_32x32x16_bf16 v[88:103], v[28:31], v[76:79], v[88:103]
    v_mfma_f32_32x32x16_bf16 v[104:119], v[36:39], v[76:79], v[104:119]
    v_mfma_f32_32x32x16_bf16 v[88:103], v[24:27], v[80:83], v[88:103]
    v_mfma_f32_32x32x16_bf16 v[104:119], v[32:35], v[80:83], v[104:119]
    v_mfma_f32_32x32x16_bf16 v[88:103], v[20:23], v[84:87], v[88:103]
    v_mfma_f32_32x32x16_bf16 v[104:119], v[28:31], v[84:87], v[104:119]
    v_subrev_u32 v9, 144, v9
    v_max_i32 v11, v9, v10
    ds_read_b128 v[20:23], v8 offset:96
    ds_read_b128 v[24:27], v8 offset:64
    ds_read_b128 v[28:31], v8 offset:32
    ds_read_b128 v[32:35], v8 offset:0
    ds_read_b128 v[72:75], v11 offset:0
    ds_read_b128 v[76:79], v11 offset:32
    ds_read_b128 v[80:83], v11 offset:64
    ds_read_b128 v[84:87], v11 offset:96
    s_waitcnt lgkmcnt(8)
    v_mfma_f32_32x32x16_bf16 v[88:103], v[48:51], v[56:59], v[88:103]
    v_mfma_f32_32x32x16_bf16 v[104:119], v[16:19], v[56:59], v[104:119]
    v_mfma_f32_32x32x16_bf16 v[88:103], v[44:47], v[60:63], v[88:103]
    v_mfma_f32_32x32x16_bf16 v[104:119], v[52:55], v[60:63], v[104:119]
    v_mfma_f32_32x32x16_bf16 v[88:103], v[40:43], v[64:67], v[88:103]
    v_mfma_f32_32x32x16_bf16 v[104:119], v[48:51], v[64:67], v[104:119]
    v_mfma_f32_32x32x16_bf16 v[88:103], v[36:39], v[68:71], v[88:103]
    v_mfma_f32_32x32x16_bf16 v[104:119], v[44:47], v[68:71], v[104:119]
    v_subrev_u32 v9, 144, v9
    v_max_i32 v11, v9, v10
    s_waitcnt vmcnt(0)
    ds_write_b128 v14, v[120:123] offset:4752
    ds_write_b128 v14, v[124:127] offset:4880
    ds_write_b128 v14, v[128:131] offset:5008
    ds_write_b128 v14, v[132:135] offset:5136
    ds_write_b128 v14, v[136:139] offset:5264
    ds_write_b128 v14, v[140:143] offset:5392
    ds_write_b128 v14, v[144:147] offset:5520
    ds_write_b128 v14, v[148:151] offset:5648
    ds_write_b128 v14, v[152:155] offset:5776
    ds_read_b128 v[36:39], v8 offset:992
    ds_read_b128 v[40:43], v8 offset:960
    ds_read_b128 v[44:47], v8 offset:928
    ds_read_b128 v[48:51], v8 offset:896
    ds_read_b128 v[56:59], v11 offset:0
    ds_read_b128 v[60:63], v11 offset:32
    ds_read_b128 v[64:67], v11 offset:64
    ds_read_b128 v[68:71], v11 offset:96
    s_waitcnt lgkmcnt(15)
    s_waitcnt lgkmcnt(8)
    v_mfma_f32_32x32x16_bf16 v[88:103], v[24:27], v[72:75], v[88:103]
    v_mfma_f32_32x32x16_bf16 v[104:119], v[32:35], v[72:75], v[104:119]
    v_mfma_f32_32x32x16_bf16 v[88:103], v[20:23], v[76:79], v[88:103]
    v_mfma_f32_32x32x16_bf16 v[104:119], v[28:31], v[76:79], v[104:119]
    v_mfma_f32_32x32x16_bf16 v[88:103], v[16:19], v[80:83], v[88:103]
    v_mfma_f32_32x32x16_bf16 v[104:119], v[24:27], v[80:83], v[104:119]
    v_mfma_f32_32x32x16_bf16 v[88:103], v[52:55], v[84:87], v[88:103]
    v_mfma_f32_32x32x16_bf16 v[104:119], v[20:23], v[84:87], v[104:119]
    v_subrev_u32 v9, 144, v9
    v_max_i32 v11, v9, v10
    ds_read_b128 v[52:55], v8 offset:864
    ds_read_b128 v[16:19], v8 offset:832
    ds_read_b128 v[20:23], v8 offset:800
    ds_read_b128 v[24:27], v8 offset:768
    ds_read_b128 v[72:75], v11 offset:0
    ds_read_b128 v[76:79], v11 offset:32
    ds_read_b128 v[80:83], v11 offset:64
    ds_read_b128 v[84:87], v11 offset:96
    s_waitcnt lgkmcnt(8)
    v_mfma_f32_32x32x16_bf16 v[88:103], v[40:43], v[56:59], v[88:103]
    v_mfma_f32_32x32x16_bf16 v[104:119], v[48:51], v[56:59], v[104:119]
    v_mfma_f32_32x32x16_bf16 v[88:103], v[36:39], v[60:63], v[88:103]
    v_mfma_f32_32x32x16_bf16 v[104:119], v[44:47], v[60:63], v[104:119]
    v_mfma_f32_32x32x16_bf16 v[88:103], v[32:35], v[64:67], v[88:103]
    v_mfma_f32_32x32x16_bf16 v[104:119], v[40:43], v[64:67], v[104:119]
    v_mfma_f32_32x32x16_bf16 v[88:103], v[28:31], v[68:71], v[88:103]
    v_mfma_f32_32x32x16_bf16 v[104:119], v[36:39], v[68:71], v[104:119]
    v_subrev_u32 v9, 144, v9
    v_max_i32 v11, v9, v10
    ds_read_b128 v[28:31], v8 offset:736
    ds_read_b128 v[32:35], v8 offset:704
    ds_read_b128 v[36:39], v8 offset:672
    ds_read_b128 v[40:43], v8 offset:640
    ds_read_b128 v[56:59], v11 offset:0
    ds_read_b128 v[60:63], v11 offset:32
    ds_read_b128 v[64:67], v11 offset:64
    ds_read_b128 v[68:71], v11 offset:96
    s_waitcnt lgkmcnt(8)
    v_mfma_f32_32x32x16_bf16 v[88:103], v[16:19], v[72:75], v[88:103]
    v_mfma_f32_32x32x16_bf16 v[104:119], v[24:27], v[72:75], v[104:119]
    v_mfma_f32_32x32x16_bf16 v[88:103], v[52:55], v[76:79], v[88:103]
    v_mfma_f32_32x32x16_bf16 v[104:119], v[20:23], v[76:79], v[104:119]
    v_mfma_f32_32x32x16_bf16 v[88:103], v[48:51], v[80:83], v[88:103]
    v_mfma_f32_32x32x16_bf16 v[104:119], v[16:19], v[80:83], v[104:119]
    v_mfma_f32_32x32x16_bf16 v[88:103], v[44:47], v[84:87], v[88:103]
    v_mfma_f32_32x32x16_bf16 v[104:119], v[52:55], v[84:87], v[104:119]
    v_subrev_u32 v9, 144, v9
    v_max_i32 v11, v9, v10
    ds_read_b128 v[44:47], v8 offset:608
    ds_read_b128 v[48:51], v8 offset:576
    ds_read_b128 v[52:55], v8 offset:544
    ds_read_b128 v[16:19], v8 offset:512
    ds_read_b128 v[72:75], v11 offset:0
    ds_read_b128 v[76:79], v11 offset:32
    ds_read_b128 v[80:83], v11 offset:64
    ds_read_b128 v[84:87], v11 offset:96
    s_waitcnt lgkmcnt(8)
    v_mfma_f32_32x32x16_bf16 v[88:103], v[32:35], v[56:59], v[88:103]
    v_mfma_f32_32x32x16_bf16 v[104:119], v[40:43], v[56:59], v[104:119]
    v_mfma_f32_32x32x16_bf16 v[88:103], v[28:31], v[60:63], v[88:103]
    v_mfma_f32_32x32x16_bf16 v[104:119], v[36:39], v[60:63], v[104:119]
    v_mfma_f32_32x32x16_bf16 v[88:103], v[24:27], v[64:67], v[88:103]
    v_mfma_f32_32x32x16_bf16 v[104:119], v[32:35], v[64:67], v[104:119]
    v_mfma_f32_32x32x16_bf16 v[88:103], v[20:23], v[68:71], v[88:103]
    v_mfma_f32_32x32x16_bf16 v[104:119], v[28:31], v[68:71], v[104:119]
    v_subrev_u32 v9, 144, v9
    v_max_i32 v11, v9, v10
    ds_read_b128 v[20:23], v8 offset:480
    ds_read_b128 v[24:27], v8 offset:448
    ds_read_b128 v[28:31], v8 offset:416
    ds_read_b128 v[32:35], v8 offset:384
    ds_read_b128 v[56:59], v11 offset:0
    ds_read_b128 v[60:63], v11 offset:32
    ds_read_b128 v[64:67], v11 offset:64
    ds_read_b128 v[68:71], v11 offset:96
    s_waitcnt lgkmcnt(8)
    v_mfma_f32_32x32x16_bf16 v[88:103], v[48:51], v[72:75], v[88:103]
    v_mfma_f32_32x32x16_bf16 v[104:119], v[16:19], v[72:75], v[104:119]
    v_mfma_f32_32x32x16_bf16 v[88:103], v[44:47], v[76:79], v[88:103]
    v_mfma_f32_32x32x16_bf16 v[104:119], v[52:55], v[76:79], v[104:119]
    v_mfma_f32_32x32x16_bf16 v[88:103], v[40:43], v[80:83], v[88:103]
    v_mfma_f32_32x32x16_bf16 v[104:119], v[48:51], v[80:83], v[104:119]
    v_mfma_f32_32x32x16_bf16 v[88:103], v[36:39], v[84:87], v[88:103]
    v_mfma_f32_32x32x16_bf16 v[104:119], v[44:47], v[84:87], v[104:119]
    v_subrev_u32 v9, 144, v9
    v_max_i32 v11, v9, v10
    ds_read_b128 v[36:39], v8 offset:352
    ds_read_b128 v[40:43], v8 offset:320
    ds_read_b128 v[44:47], v8 offset:288
    ds_read_b128 v[48:51], v8 offset:256
    ds_read_b128 v[72:75], v11 offset:0
    ds_read_b128 v[76:79], v11 offset:32
    ds_read_b128 v[80:83], v11 offset:64
    ds_read_b128 v[84:87], v11 offset:96
    s_waitcnt lgkmcnt(8)
    v_mfma_f32_32x32x16_bf16 v[88:103], v[24:27], v[56:59], v[88:103]
    v_mfma_f32_32x32x16_bf16 v[104:119], v[32:35], v[56:59], v[104:119]
    v_mfma_f32_32x32x16_bf16 v[88:103], v[20:23], v[60:63], v[88:103]
    v_mfma_f32_32x32x16_bf16 v[104:119], v[28:31], v[60:63], v[104:119]
    v_mfma_f32_32x32x16_bf16 v[88:103], v[16:19], v[64:67], v[88:103]
    v_mfma_f32_32x32x16_bf16 v[104:119], v[24:27], v[64:67], v[104:119]
    v_mfma_f32_32x32x16_bf16 v[88:103], v[52:55], v[68:71], v[88:103]
    v_mfma_f32_32x32x16_bf16 v[104:119], v[20:23], v[68:71], v[104:119]
    v_subrev_u32 v9, 144, v9
    v_max_i32 v11, v9, v10
    ds_read_b128 v[52:55], v8 offset:224
    ds_read_b128 v[16:19], v8 offset:192
    ds_read_b128 v[20:23], v8 offset:160
    ds_read_b128 v[24:27], v8 offset:128
    ds_read_b128 v[56:59], v11 offset:0
    ds_read_b128 v[60:63], v11 offset:32
    ds_read_b128 v[64:67], v11 offset:64
    ds_read_b128 v[68:71], v11 offset:96
    s_waitcnt lgkmcnt(8)
    v_mfma_f32_32x32x16_bf16 v[88:103], v[40:43], v[72:75], v[88:103]
    v_mfma_f32_32x32x16_bf16 v[104:119], v[48:51], v[72:75], v[104:119]
    v_mfma_f32_32x32x16_bf16 v[88:103], v[36:39], v[76:79], v[88:103]
    v_mfma_f32_32x32x16_bf16 v[104:119], v[44:47], v[76:79], v[104:119]
    v_mfma_f32_32x32x16_bf16 v[88:103], v[32:35], v[80:83], v[88:103]
    v_mfma_f32_32x32x16_bf16 v[104:119], v[40:43], v[80:83], v[104:119]
    v_mfma_f32_32x32x16_bf16 v[88:103], v[28:31], v[84:87], v[88:103]
    v_mfma_f32_32x32x16_bf16 v[104:119], v[36:39], v[84:87], v[104:119]
    v_subrev_u32 v9, 144, v9
    v_max_i32 v11, v9, v10
    ds_read_b128 v[28:31], v8 offset:96
    ds_read_b128 v[32:35], v8 offset:64
    ds_read_b128 v[36:39], v8 offset:32
    ds_read_b128 v[40:43], v8 offset:0
    ds_read_b128 v[72:75], v11 offset:0
    ds_read_b128 v[76:79], v11 offset:32
    ds_read_b128 v[80:83], v11 offset:64
    ds_read_b128 v[84:87], v11 offset:96
    s_waitcnt lgkmcnt(8)
    v_mfma_f32_32x32x16_bf16 v[88:103], v[16:19], v[56:59], v[88:103]
    v_mfma_f32_32x32x16_bf16 v[104:119], v[24:27], v[56:59], v[104:119]
    v_mfma_f32_32x32x16_bf16 v[88:103], v[52:55], v[60:63], v[88:103]
    v_mfma_f32_32x32x16_bf16 v[104:119], v[20:23], v[60:63], v[104:119]
    v_mfma_f32_32x32x16_bf16 v[88:103], v[48:51], v[64:67], v[88:103]
    v_mfma_f32_32x32x16_bf16 v[104:119], v[16:19], v[64:67], v[104:119]
    v_mfma_f32_32x32x16_bf16 v[88:103], v[44:47], v[68:71], v[88:103]
    v_mfma_f32_32x32x16_bf16 v[104:119], v[52:55], v[68:71], v[104:119]
    s_waitcnt lgkmcnt(0)
    v_mfma_f32_32x32x16_bf16 v[88:103], v[32:35], v[72:75], v[88:103]
    v_mfma_f32_32x32x16_bf16 v[104:119], v[40:43], v[72:75], v[104:119]
    v_mfma_f32_32x32x16_bf16 v[88:103], v[28:31], v[76:79], v[88:103]
    v_mfma_f32_32x32x16_bf16 v[104:119], v[36:39], v[76:79], v[104:119]
    v_mfma_f32_32x32x16_bf16 v[88:103], v[24:27], v[80:83], v[88:103]
    v_mfma_f32_32x32x16_bf16 v[104:119], v[32:35], v[80:83], v[104:119]
    v_mfma_f32_32x32x16_bf16 v[88:103], v[20:23], v[84:87], v[88:103]
    v_mfma_f32_32x32x16_bf16 v[104:119], v[28:31], v[84:87], v[104:119]
    v_mul_u32_u24 v9, 144, v6
    v_lshl_add_u32 v9, v7, 3, v9
    v_add_u32 v9, s32, v9
    ds_read_b64 v[16:17], v9 offset:144
    ds_read_b64 v[18:19], v9 offset:160
    ds_read_b64 v[20:21], v9 offset:176
    ds_read_b64 v[22:23], v9 offset:192
    ds_read_b64 v[24:25], v9 offset:208
    ds_read_b64 v[26:27], v9 offset:224
    ds_read_b64 v[28:29], v9 offset:240
    ds_read_b64 v[30:31], v9 offset:256
    v_lshlrev_b32 v12, 7, v6
    v_lshl_add_u32 v12, v7, 3, v12
    s_and_b32 s35, s27, 1
    s_lshl_b32 s36, s29, 16
    s_and_b32 s37, s29, 0xffff0000
    s_cmp_eq_u32 s35, 0
    s_cselect_b32 s36, s36, s37
    s_waitcnt lgkmcnt(0)
    v_cvt_pk_bf16_f32 v32, v88, v89
    v_lshlrev_b32 v33, 16, v16
    v_and_b32 v34, 0xffff0000, v16
    v_mul_f32 v33, s36, v33
    v_mul_f32 v34, s36, v34
    v_cvt_pk_bf16_f32 v33, v33, v34
    v_lshlrev_b32 v34, 16, v32
    v_and_b32 v32, 0xffff0000, v32
    v_lshlrev_b32 v35, 16, v33
    v_and_b32 v33, 0xffff0000, v33
    v_add_f32 v34, v34, v35
    v_add_f32 v32, v32, v33
    v_cvt_pk_bf16_f32 v88, v34, v32
    v_cvt_pk_bf16_f32 v32, v90, v91
    v_lshlrev_b32 v33, 16, v17
    v_and_b32 v34, 0xffff0000, v17
    v_mul_f32 v33, s36, v33
    v_mul_f32 v34, s36, v34
    v_cvt_pk_bf16_f32 v33, v33, v34
    v_lshlrev_b32 v34, 16, v32
    v_and_b32 v32, 0xffff0000, v32
    v_lshlrev_b32 v35, 16, v33
    v_and_b32 v33, 0xffff0000, v33
    v_add_f32 v34, v34, v35
    v_add_f32 v32, v32, v33
    v_cvt_pk_bf16_f32 v90, v34, v32
    v_mov_b32 v89, v90
    buffer_store_dwordx2 v[88:89], v12, s[12:15], s31 offen offset:0
    v_cvt_pk_bf16_f32 v32, v92, v93
    v_lshlrev_b32 v33, 16, v18
    v_and_b32 v34, 0xffff0000, v18
    v_mul_f32 v33, s36, v33
    v_mul_f32 v34, s36, v34
    v_cvt_pk_bf16_f32 v33, v33, v34
    v_lshlrev_b32 v34, 16, v32
    v_and_b32 v32, 0xffff0000, v32
    v_lshlrev_b32 v35, 16, v33
    v_and_b32 v33, 0xffff0000, v33
    v_add_f32 v34, v34, v35
    v_add_f32 v32, v32, v33
    v_cvt_pk_bf16_f32 v92, v34, v32
    v_cvt_pk_bf16_f32 v32, v94, v95
    v_lshlrev_b32 v33, 16, v19
    v_and_b32 v34, 0xffff0000, v19
    v_mul_f32 v33, s36, v33
    v_mul_f32 v34, s36, v34
    v_cvt_pk_bf16_f32 v33, v33, v34
    v_lshlrev_b32 v34, 16, v32
    v_and_b32 v32, 0xffff0000, v32
    v_lshlrev_b32 v35, 16, v33
    v_and_b32 v33, 0xffff0000, v33
    v_add_f32 v34, v34, v35
    v_add_f32 v32, v32, v33
    v_cvt_pk_bf16_f32 v94, v34, v32
    v_mov_b32 v93, v94
    buffer_store_dwordx2 v[92:93], v12, s[12:15], s31 offen offset:16
    v_cvt_pk_bf16_f32 v32, v96, v97
    v_lshlrev_b32 v33, 16, v20
    v_and_b32 v34, 0xffff0000, v20
    v_mul_f32 v33, s36, v33
    v_mul_f32 v34, s36, v34
    v_cvt_pk_bf16_f32 v33, v33, v34
    v_lshlrev_b32 v34, 16, v32
    v_and_b32 v32, 0xffff0000, v32
    v_lshlrev_b32 v35, 16, v33
    v_and_b32 v33, 0xffff0000, v33
    v_add_f32 v34, v34, v35
    v_add_f32 v32, v32, v33
    v_cvt_pk_bf16_f32 v96, v34, v32
    v_cvt_pk_bf16_f32 v32, v98, v99
    v_lshlrev_b32 v33, 16, v21
    v_and_b32 v34, 0xffff0000, v21
    v_mul_f32 v33, s36, v33
    v_mul_f32 v34, s36, v34
    v_cvt_pk_bf16_f32 v33, v33, v34
    v_lshlrev_b32 v34, 16, v32
    v_and_b32 v32, 0xffff0000, v32
    v_lshlrev_b32 v35, 16, v33
    v_and_b32 v33, 0xffff0000, v33
    v_add_f32 v34, v34, v35
    v_add_f32 v32, v32, v33
    v_cvt_pk_bf16_f32 v98, v34, v32
    v_mov_b32 v97, v98
    buffer_store_dwordx2 v[96:97], v12, s[12:15], s31 offen offset:32
    v_cvt_pk_bf16_f32 v32, v100, v101
    v_lshlrev_b32 v33, 16, v22
    v_and_b32 v34, 0xffff0000, v22
    v_mul_f32 v33, s36, v33
    v_mul_f32 v34, s36, v34
    v_cvt_pk_bf16_f32 v33, v33, v34
    v_lshlrev_b32 v34, 16, v32
    v_and_b32 v32, 0xffff0000, v32
    v_lshlrev_b32 v35, 16, v33
    v_and_b32 v33, 0xffff0000, v33
    v_add_f32 v34, v34, v35
    v_add_f32 v32, v32, v33
    v_cvt_pk_bf16_f32 v100, v34, v32
    v_cvt_pk_bf16_f32 v32, v102, v103
    v_lshlrev_b32 v33, 16, v23
    v_and_b32 v34, 0xffff0000, v23
    v_mul_f32 v33, s36, v33
    v_mul_f32 v34, s36, v34
    v_cvt_pk_bf16_f32 v33, v33, v34
    v_lshlrev_b32 v34, 16, v32
    v_and_b32 v32, 0xffff0000, v32
    v_lshlrev_b32 v35, 16, v33
    v_and_b32 v33, 0xffff0000, v33
    v_add_f32 v34, v34, v35
    v_add_f32 v32, v32, v33
    v_cvt_pk_bf16_f32 v102, v34, v32
    v_mov_b32 v101, v102
    buffer_store_dwordx2 v[100:101], v12, s[12:15], s31 offen offset:48
    v_cvt_pk_bf16_f32 v32, v104, v105
    v_lshlrev_b32 v33, 16, v24
    v_and_b32 v34, 0xffff0000, v24
    v_mul_f32 v33, s36, v33
    v_mul_f32 v34, s36, v34
    v_cvt_pk_bf16_f32 v33, v33, v34
    v_lshlrev_b32 v34, 16, v32
    v_and_b32 v32, 0xffff0000, v32
    v_lshlrev_b32 v35, 16, v33
    v_and_b32 v33, 0xffff0000, v33
    v_add_f32 v34, v34, v35
    v_add_f32 v32, v32, v33
    v_cvt_pk_bf16_f32 v104, v34, v32
    v_cvt_pk_bf16_f32 v32, v106, v107
    v_lshlrev_b32 v33, 16, v25
    v_and_b32 v34, 0xffff0000, v25
    v_mul_f32 v33, s36, v33
    v_mul_f32 v34, s36, v34
    v_cvt_pk_bf16_f32 v33, v33, v34
    v_lshlrev_b32 v34, 16, v32
    v_and_b32 v32, 0xffff0000, v32
    v_lshlrev_b32 v35, 16, v33
    v_and_b32 v33, 0xffff0000, v33
    v_add_f32 v34, v34, v35
    v_add_f32 v32, v32, v33
    v_cvt_pk_bf16_f32 v106, v34, v32
    v_mov_b32 v105, v106
    buffer_store_dwordx2 v[104:105], v12, s[12:15], s31 offen offset:64
    v_cvt_pk_bf16_f32 v32, v108, v109
    v_lshlrev_b32 v33, 16, v26
    v_and_b32 v34, 0xffff0000, v26
    v_mul_f32 v33, s36, v33
    v_mul_f32 v34, s36, v34
    v_cvt_pk_bf16_f32 v33, v33, v34
    v_lshlrev_b32 v34, 16, v32
    v_and_b32 v32, 0xffff0000, v32
    v_lshlrev_b32 v35, 16, v33
    v_and_b32 v33, 0xffff0000, v33
    v_add_f32 v34, v34, v35
    v_add_f32 v32, v32, v33
    v_cvt_pk_bf16_f32 v108, v34, v32
    v_cvt_pk_bf16_f32 v32, v110, v111
    v_lshlrev_b32 v33, 16, v27
    v_and_b32 v34, 0xffff0000, v27
    v_mul_f32 v33, s36, v33
    v_mul_f32 v34, s36, v34
    v_cvt_pk_bf16_f32 v33, v33, v34
    v_lshlrev_b32 v34, 16, v32
    v_and_b32 v32, 0xffff0000, v32
    v_lshlrev_b32 v35, 16, v33
    v_and_b32 v33, 0xffff0000, v33
    v_add_f32 v34, v34, v35
    v_add_f32 v32, v32, v33
    v_cvt_pk_bf16_f32 v110, v34, v32
    v_mov_b32 v109, v110
    buffer_store_dwordx2 v[108:109], v12, s[12:15], s31 offen offset:80
    v_cvt_pk_bf16_f32 v32, v112, v113
    v_lshlrev_b32 v33, 16, v28
    v_and_b32 v34, 0xffff0000, v28
    v_mul_f32 v33, s36, v33
    v_mul_f32 v34, s36, v34
    v_cvt_pk_bf16_f32 v33, v33, v34
    v_lshlrev_b32 v34, 16, v32
    v_and_b32 v32, 0xffff0000, v32
    v_lshlrev_b32 v35, 16, v33
    v_and_b32 v33, 0xffff0000, v33
    v_add_f32 v34, v34, v35
    v_add_f32 v32, v32, v33
    v_cvt_pk_bf16_f32 v112, v34, v32
    v_cvt_pk_bf16_f32 v32, v114, v115
    v_lshlrev_b32 v33, 16, v29
    v_and_b32 v34, 0xffff0000, v29
    v_mul_f32 v33, s36, v33
    v_mul_f32 v34, s36, v34
    v_cvt_pk_bf16_f32 v33, v33, v34
    v_lshlrev_b32 v34, 16, v32
    v_and_b32 v32, 0xffff0000, v32
    v_lshlrev_b32 v35, 16, v33
    v_and_b32 v33, 0xffff0000, v33
    v_add_f32 v34, v34, v35
    v_add_f32 v32, v32, v33
    v_cvt_pk_bf16_f32 v114, v34, v32
    v_mov_b32 v113, v114
    buffer_store_dwordx2 v[112:113], v12, s[12:15], s31 offen offset:96
    v_cvt_pk_bf16_f32 v32, v116, v117
    v_lshlrev_b32 v33, 16, v30
    v_and_b32 v34, 0xffff0000, v30
    v_mul_f32 v33, s36, v33
    v_mul_f32 v34, s36, v34
    v_cvt_pk_bf16_f32 v33, v33, v34
    v_lshlrev_b32 v34, 16, v32
    v_and_b32 v32, 0xffff0000, v32
    v_lshlrev_b32 v35, 16, v33
    v_and_b32 v33, 0xffff0000, v33
    v_add_f32 v34, v34, v35
    v_add_f32 v32, v32, v33
    v_cvt_pk_bf16_f32 v116, v34, v32
    v_cvt_pk_bf16_f32 v32, v118, v119
    v_lshlrev_b32 v33, 16, v31
    v_and_b32 v34, 0xffff0000, v31
    v_mul_f32 v33, s36, v33
    v_mul_f32 v34, s36, v34
    v_cvt_pk_bf16_f32 v33, v33, v34
    v_lshlrev_b32 v34, 16, v32
    v_and_b32 v32, 0xffff0000, v32
    v_lshlrev_b32 v35, 16, v33
    v_and_b32 v33, 0xffff0000, v33
    v_add_f32 v34, v34, v35
    v_add_f32 v32, v32, v33
    v_cvt_pk_bf16_f32 v118, v34, v32
    v_mov_b32 v117, v118
    buffer_store_dwordx2 v[116:117], v12, s[12:15], s31 offen offset:112
    s_waitcnt vmcnt(0)
    s_endpgm
GATE_17:
    s_cmp_ge_u32 s2, 408
    s_cbranch_scc1 END_8
    s_sub_u32 s3, s2, 400
    s_load_dwordx2 s[24:25], s[0:1], 104
    s_waitcnt lgkmcnt(0)
    s_add_u32 s4, s24, 0x1010000
    s_addc_u32 s5, s25, 0
    s_mov_b32 s6, 0x6000
    s_mov_b32 s7, 0x00020000
    s_add_u32 s8, s24, 0x1000000
    s_addc_u32 s9, s25, 0
    s_mov_b32 s10, 0x2000
    s_mov_b32 s11, 0x00020000
    s_lshl_b32 s16, s3, 10
    v_lshl_add_u32 v1, v0, 2, s16
    buffer_load_dword v6, v1, s[4:7], 0 offen
    s_mov_b32 s17, 8192
    buffer_load_dword v7, v1, s[4:7], s17 offen
    s_mov_b32 s18, 16384
    buffer_load_dword v8, v1, s[4:7], s18 offen
    s_waitcnt vmcnt(0)
    v_add_f32 v6, v6, v7
    v_add_f32 v6, v6, v8
    v_cvt_pk_bf16_f32 v6, v6, v6
    v_and_b32 v6, 0xffff0000, v6
    v_mul_f32 v6, 0xbfb8aa3b, v6
    v_exp_f32 v6, v6
    s_nop 0
    v_add_f32 v6, 1.0, v6
    v_rcp_f32 v6, v6
    s_nop 0
    v_cvt_pk_bf16_f32 v6, v6, v6
    v_and_b32 v6, 0xffff0000, v6
    buffer_store_dword v6, v1, s[8:11], 0 offen
    s_waitcnt vmcnt(0)
END_8:
    s_endpgm
.globl l3_kernel
.p2align 8
.type l3_kernel,@function
l3_kernel:
    s_cmp_ge_u32 s2, 288
    s_cbranch_scc1 END_18
    s_load_dwordx2 s[20:21], s[0:1], 16
    s_load_dwordx2 s[22:23], s[0:1], 88
    s_load_dwordx2 s[24:25], s[0:1], 104
    s_waitcnt lgkmcnt(0)
    s_add_u32 s4, s24, 0x800000
    s_addc_u32 s5, s25, 0
    s_mov_b32 s6, 0x240000
    s_mov_b32 s7, 0x00020000
    s_mov_b32 s8, s20
    s_mov_b32 s9, s21
    s_mov_b32 s10, 0xa2000
    s_mov_b32 s11, 0x00020000
    s_mov_b32 s12, s22
    s_mov_b32 s13, s23
    s_mov_b32 s14, 0x240000
    s_mov_b32 s15, 0x00020000
    s_add_u32 s16, s24, 0x1000000
    s_addc_u32 s17, s25, 0
    s_mov_b32 s18, 0x2000
    s_mov_b32 s19, 0x00020000
    s_add_u32 s36, s24, 0x1400000
    s_addc_u32 s37, s25, 0
    s_mov_b32 s38, 0x240000
    s_mov_b32 s39, 0x00020000
    s_and_b32 s26, s2, 31
    s_lshl_b32 s26, s26, 6
    s_lshr_b32 s27, s2, 5
    s_lshl_b32 s27, s27, 6
    v_lshrrev_b32 v11, 3, v0
    v_and_b32 v12, 7, v0
    v_lshlrev_b32 v12, 4, v12
    v_mul_u32_u24 v3, 144, v11
    v_add_u32 v3, v3, v12
    v_add_u32 v11, s26, v11
    v_mul_u32_u24 v1, 1152, v11
    v_add_u32 v1, v1, v12
    v_lshrrev_b32 v11, 3, v0
    v_add_u32 v11, 32, v11
    v_and_b32 v12, 7, v0
    v_lshlrev_b32 v12, 4, v12
    v_mul_u32_u24 v4, 144, v11
    v_add_u32 v4, v4, v12
    v_add_u32 v11, s26, v11
    v_mul_u32_u24 v2, 1152, v11
    v_add_u32 v2, v2, v12
    v_add_u32 v13, 0, v0
    v_lshrrev_b32 v11, 3, v13
    v_and_b32 v12, 7, v13
    v_lshlrev_b32 v12, 4, v12
    v_mul_u32_u24 v7, 192, v11
    v_add_u32 v7, v7, v12
    v_mul_u32_u24 v5, 1152, v11
    v_add_u32 v5, v5, v12
    v_add_u32 v5, s27, v5
    v_add_u32 v5, s27, v5
    v_add_u32 v13, 256, v0
    v_lshrrev_b32 v11, 3, v13
    v_and_b32 v12, 7, v13
    v_lshlrev_b32 v12, 4, v12
    v_mul_u32_u24 v8, 192, v11
    v_add_u32 v8, v8, v12
    v_mul_u32_u24 v6, 1152, v11
    v_add_u32 v6, v6, v12
    v_add_u32 v6, s27, v6
    v_add_u32 v6, s27, v6
    v_lshrrev_b32 v11, 6, v0
    v_lshrrev_b32 v12, 1, v11
    v_and_b32 v11, 1, v11
    v_mul_u32_u24 v12, 32, v12
    v_and_b32 v13, 31, v0
    v_add_u32 v12, v12, v13
    v_mul_u32_u24 v9, 144, v12
    v_bfe_u32 v13, v0, 5, 1
    v_lshl_add_u32 v9, v13, 4, v9
    v_bfe_u32 v12, v0, 2, 2
    v_lshl_add_u32 v12, v13, 3, v12
    v_mul_u32_u24 v10, 192, v12
    v_mul_u32_u24 v11, 64, v11
    v_add_u32 v10, v10, v11
    v_bfe_u32 v11, v0, 4, 1
    v_lshl_add_u32 v10, v11, 5, v10
    v_and_b32 v11, 3, v0
    v_lshl_add_u32 v10, v11, 3, v10
    v_add_u32 v10, 9216, v10
    v_lshrrev_b32 v11, 6, v0
    v_lshrrev_b32 v12, 1, v11
    v_and_b32 v11, 1, v11
    v_mul_u32_u24 v11, 32, v11
    v_and_b32 v13, 31, v0
    v_add3_u32 v11, v11, v13, s27
    v_mul_u32_u24 v12, 32, v12
    v_bfe_u32 v13, v0, 5, 1
    v_lshl_add_u32 v12, v13, 2, v12
    v_add_u32 v12, s26, v12
    v_lshlrev_b32 v13, 2, v12
    buffer_load_dwordx4 v[96:99], v13, s[16:19], 0 offen offset:0
    buffer_load_dwordx4 v[100:103], v13, s[16:19], 0 offen offset:32
    buffer_load_dwordx4 v[104:107], v13, s[16:19], 0 offen offset:64
    buffer_load_dwordx4 v[108:111], v13, s[16:19], 0 offen offset:96
    v_lshlrev_b32 v13, 12, v11
    v_lshl_add_u32 v13, v12, 1, v13
    s_mov_b32 s28, 0x0
    buffer_load_dwordx2 v[112:113], v13, s[36:39], s28 offen offset:0
    buffer_load_dwordx2 v[114:115], v13, s[36:39], s28 offen offset:16
    buffer_load_dwordx2 v[116:117], v13, s[36:39], s28 offen offset:32
    buffer_load_dwordx2 v[118:119], v13, s[36:39], s28 offen offset:48
    v_mul_u32_u24 v120, 1152, v12
    v_lshl_add_u32 v120, v11, 1, v120
    buffer_load_dwordx4 v[48:51], v1, s[4:7], 0 offen offset:0
    buffer_load_dwordx4 v[52:55], v2, s[4:7], 0 offen offset:0
    s_mov_b32 s28, 0x0
    buffer_load_dwordx4 v[56:59], v5, s[8:11], s28 offen
    buffer_load_dwordx4 v[60:63], v6, s[8:11], s28 offen
    buffer_load_dwordx4 v[64:67], v1, s[4:7], 0 offen offset:128
    buffer_load_dwordx4 v[68:71], v2, s[4:7], 0 offen offset:128
    s_mov_b32 s28, 0x12000
    buffer_load_dwordx4 v[72:75], v5, s[8:11], s28 offen
    buffer_load_dwordx4 v[76:79], v6, s[8:11], s28 offen
    buffer_load_dwordx4 v[80:83], v1, s[4:7], 0 offen offset:256
    buffer_load_dwordx4 v[84:87], v2, s[4:7], 0 offen offset:256
    s_mov_b32 s28, 0x24000
    buffer_load_dwordx4 v[88:91], v5, s[8:11], s28 offen
    buffer_load_dwordx4 v[92:95], v6, s[8:11], s28 offen
    s_waitcnt vmcnt(8)
    ds_write_b128 v3, v[48:51] offset:0
    ds_write_b128 v4, v[52:55] offset:0
    ds_write_b128 v7, v[56:59] offset:9216
    ds_write_b128 v8, v[60:63] offset:9216
    buffer_load_dwordx4 v[48:51], v1, s[4:7], 0 offen offset:384
    buffer_load_dwordx4 v[52:55], v2, s[4:7], 0 offen offset:384
    s_mov_b32 s28, 0x36000
    buffer_load_dwordx4 v[56:59], v5, s[8:11], s28 offen
    buffer_load_dwordx4 v[60:63], v6, s[8:11], s28 offen
    s_waitcnt lgkmcnt(0)
    s_barrier
    ds_read_b128 v[16:19], v9 offset:0
    ds_read_b64_tr_b16 v[24:25], v10 offset:0
    ds_read_b64_tr_b16 v[26:27], v10 offset:768
    s_waitcnt vmcnt(8)
    ds_write_b128 v3, v[64:67] offset:21504
    ds_write_b128 v4, v[68:71] offset:21504
    ds_write_b128 v7, v[72:75] offset:30720
    ds_write_b128 v8, v[76:79] offset:30720
    buffer_load_dwordx4 v[64:67], v1, s[4:7], 0 offen offset:512
    buffer_load_dwordx4 v[68:71], v2, s[4:7], 0 offen offset:512
    s_mov_b32 s28, 0x48000
    buffer_load_dwordx4 v[72:75], v5, s[8:11], s28 offen
    buffer_load_dwordx4 v[76:79], v6, s[8:11], s28 offen
    ds_read_b128 v[20:23], v9 offset:32
    ds_read_b64_tr_b16 v[28:29], v10 offset:3072
    ds_read_b64_tr_b16 v[30:31], v10 offset:3840
    s_waitcnt lgkmcnt(7)
    v_mfma_f32_32x32x16_bf16 v[32:47], v[16:19], v[24:27], 0
    ds_read_b128 v[16:19], v9 offset:64
    ds_read_b64_tr_b16 v[24:25], v10 offset:6144
    ds_read_b64_tr_b16 v[26:27], v10 offset:6912
    s_waitcnt lgkmcnt(3)
    v_mfma_f32_32x32x16_bf16 v[32:47], v[20:23], v[28:31], v[32:47]
    ds_read_b128 v[20:23], v9 offset:96
    ds_read_b64_tr_b16 v[28:29], v10 offset:9216
    ds_read_b64_tr_b16 v[30:31], v10 offset:9984
    s_waitcnt lgkmcnt(3)
    v_mfma_f32_32x32x16_bf16 v[32:47], v[16:19], v[24:27], v[32:47]
    s_waitcnt lgkmcnt(0)
    s_barrier
    ds_read_b128 v[16:19], v9 offset:21504
    ds_read_b64_tr_b16 v[24:25], v10 offset:21504
    ds_read_b64_tr_b16 v[26:27], v10 offset:22272
    v_mfma_f32_32x32x16_bf16 v[32:47], v[20:23], v[28:31], v[32:47]
    s_waitcnt vmcnt(8)
    ds_write_b128 v3, v[80:83] offset:43008
    ds_write_b128 v4, v[84:87] offset:43008
    ds_write_b128 v7, v[88:91] offset:52224
    ds_write_b128 v8, v[92:95] offset:52224
    buffer_load_dwordx4 v[80:83], v1, s[4:7], 0 offen offset:640
    buffer_load_dwordx4 v[84:87], v2, s[4:7], 0 offen offset:640
    s_mov_b32 s28, 0x5a000
    buffer_load_dwordx4 v[88:91], v5, s[8:11], s28 offen
    buffer_load_dwordx4 v[92:95], v6, s[8:11], s28 offen
    ds_read_b128 v[20:23], v9 offset:21536
    ds_read_b64_tr_b16 v[28:29], v10 offset:24576
    ds_read_b64_tr_b16 v[30:31], v10 offset:25344
    s_waitcnt lgkmcnt(7)
    v_mfma_f32_32x32x16_bf16 v[32:47], v[16:19], v[24:27], v[32:47]
    ds_read_b128 v[16:19], v9 offset:21568
    ds_read_b64_tr_b16 v[24:25], v10 offset:27648
    ds_read_b64_tr_b16 v[26:27], v10 offset:28416
    s_waitcnt lgkmcnt(3)
    v_mfma_f32_32x32x16_bf16 v[32:47], v[20:23], v[28:31], v[32:47]
    ds_read_b128 v[20:23], v9 offset:21600
    ds_read_b64_tr_b16 v[28:29], v10 offset:30720
    ds_read_b64_tr_b16 v[30:31], v10 offset:31488
    s_waitcnt lgkmcnt(3)
    v_mfma_f32_32x32x16_bf16 v[32:47], v[16:19], v[24:27], v[32:47]
    s_waitcnt lgkmcnt(0)
    s_barrier
    ds_read_b128 v[16:19], v9 offset:43008
    ds_read_b64_tr_b16 v[24:25], v10 offset:43008
    ds_read_b64_tr_b16 v[26:27], v10 offset:43776
    v_mfma_f32_32x32x16_bf16 v[32:47], v[20:23], v[28:31], v[32:47]
    s_waitcnt vmcnt(8)
    ds_write_b128 v3, v[48:51] offset:0
    ds_write_b128 v4, v[52:55] offset:0
    ds_write_b128 v7, v[56:59] offset:9216
    ds_write_b128 v8, v[60:63] offset:9216
    buffer_load_dwordx4 v[48:51], v1, s[4:7], 0 offen offset:768
    buffer_load_dwordx4 v[52:55], v2, s[4:7], 0 offen offset:768
    s_mov_b32 s28, 0x6c000
    buffer_load_dwordx4 v[56:59], v5, s[8:11], s28 offen
    buffer_load_dwordx4 v[60:63], v6, s[8:11], s28 offen
    ds_read_b128 v[20:23], v9 offset:43040
    ds_read_b64_tr_b16 v[28:29], v10 offset:46080
    ds_read_b64_tr_b16 v[30:31], v10 offset:46848
    s_waitcnt lgkmcnt(7)
    v_mfma_f32_32x32x16_bf16 v[32:47], v[16:19], v[24:27], v[32:47]
    ds_read_b128 v[16:19], v9 offset:43072
    ds_read_b64_tr_b16 v[24:25], v10 offset:49152
    ds_read_b64_tr_b16 v[26:27], v10 offset:49920
    s_waitcnt lgkmcnt(3)
    v_mfma_f32_32x32x16_bf16 v[32:47], v[20:23], v[28:31], v[32:47]
    ds_read_b128 v[20:23], v9 offset:43104
    ds_read_b64_tr_b16 v[28:29], v10 offset:52224
    ds_read_b64_tr_b16 v[30:31], v10 offset:52992
    s_waitcnt lgkmcnt(3)
    v_mfma_f32_32x32x16_bf16 v[32:47], v[16:19], v[24:27], v[32:47]
    s_waitcnt lgkmcnt(0)
    s_barrier
    ds_read_b128 v[16:19], v9 offset:0
    ds_read_b64_tr_b16 v[24:25], v10 offset:0
    ds_read_b64_tr_b16 v[26:27], v10 offset:768
    v_mfma_f32_32x32x16_bf16 v[32:47], v[20:23], v[28:31], v[32:47]
    s_waitcnt vmcnt(8)
    ds_write_b128 v3, v[64:67] offset:21504
    ds_write_b128 v4, v[68:71] offset:21504
    ds_write_b128 v7, v[72:75] offset:30720
    ds_write_b128 v8, v[76:79] offset:30720
    buffer_load_dwordx4 v[64:67], v1, s[4:7], 0 offen offset:896
    buffer_load_dwordx4 v[68:71], v2, s[4:7], 0 offen offset:896
    s_mov_b32 s28, 0x7e000
    buffer_load_dwordx4 v[72:75], v5, s[8:11], s28 offen
    buffer_load_dwordx4 v[76:79], v6, s[8:11], s28 offen
    ds_read_b128 v[20:23], v9 offset:32
    ds_read_b64_tr_b16 v[28:29], v10 offset:3072
    ds_read_b64_tr_b16 v[30:31], v10 offset:3840
    s_waitcnt lgkmcnt(7)
    v_mfma_f32_32x32x16_bf16 v[32:47], v[16:19], v[24:27], v[32:47]
    ds_read_b128 v[16:19], v9 offset:64
    ds_read_b64_tr_b16 v[24:25], v10 offset:6144
    ds_read_b64_tr_b16 v[26:27], v10 offset:6912
    s_waitcnt lgkmcnt(3)
    v_mfma_f32_32x32x16_bf16 v[32:47], v[20:23], v[28:31], v[32:47]
    ds_read_b128 v[20:23], v9 offset:96
    ds_read_b64_tr_b16 v[28:29], v10 offset:9216
    ds_read_b64_tr_b16 v[30:31], v10 offset:9984
    s_waitcnt lgkmcnt(3)
    v_mfma_f32_32x32x16_bf16 v[32:47], v[16:19], v[24:27], v[32:47]
    s_waitcnt lgkmcnt(0)
    s_barrier
    ds_read_b128 v[16:19], v9 offset:21504
    ds_read_b64_tr_b16 v[24:25], v10 offset:21504
    ds_read_b64_tr_b16 v[26:27], v10 offset:22272
    v_mfma_f32_32x32x16_bf16 v[32:47], v[20:23], v[28:31], v[32:47]
    s_waitcnt vmcnt(8)
    ds_write_b128 v3, v[80:83] offset:43008
    ds_write_b128 v4, v[84:87] offset:43008
    ds_write_b128 v7, v[88:91] offset:52224
    ds_write_b128 v8, v[92:95] offset:52224
    buffer_load_dwordx4 v[80:83], v1, s[4:7], 0 offen offset:1024
    buffer_load_dwordx4 v[84:87], v2, s[4:7], 0 offen offset:1024
    s_mov_b32 s28, 0x90000
    buffer_load_dwordx4 v[88:91], v5, s[8:11], s28 offen
    buffer_load_dwordx4 v[92:95], v6, s[8:11], s28 offen
    ds_read_b128 v[20:23], v9 offset:21536
    ds_read_b64_tr_b16 v[28:29], v10 offset:24576
    ds_read_b64_tr_b16 v[30:31], v10 offset:25344
    s_waitcnt lgkmcnt(7)
    v_mfma_f32_32x32x16_bf16 v[32:47], v[16:19], v[24:27], v[32:47]
    ds_read_b128 v[16:19], v9 offset:21568
    ds_read_b64_tr_b16 v[24:25], v10 offset:27648
    ds_read_b64_tr_b16 v[26:27], v10 offset:28416
    s_waitcnt lgkmcnt(3)
    v_mfma_f32_32x32x16_bf16 v[32:47], v[20:23], v[28:31], v[32:47]
    ds_read_b128 v[20:23], v9 offset:21600
    ds_read_b64_tr_b16 v[28:29], v10 offset:30720
    ds_read_b64_tr_b16 v[30:31], v10 offset:31488
    s_waitcnt lgkmcnt(3)
    v_mfma_f32_32x32x16_bf16 v[32:47], v[16:19], v[24:27], v[32:47]
    s_waitcnt lgkmcnt(0)
    s_barrier
    ds_read_b128 v[16:19], v9 offset:43008
    ds_read_b64_tr_b16 v[24:25], v10 offset:43008
    ds_read_b64_tr_b16 v[26:27], v10 offset:43776
    v_mfma_f32_32x32x16_bf16 v[32:47], v[20:23], v[28:31], v[32:47]
    s_waitcnt vmcnt(8)
    ds_write_b128 v3, v[48:51] offset:0
    ds_write_b128 v4, v[52:55] offset:0
    ds_write_b128 v7, v[56:59] offset:9216
    ds_write_b128 v8, v[60:63] offset:9216
    ds_read_b128 v[20:23], v9 offset:43040
    ds_read_b64_tr_b16 v[28:29], v10 offset:46080
    ds_read_b64_tr_b16 v[30:31], v10 offset:46848
    s_waitcnt lgkmcnt(7)
    v_mfma_f32_32x32x16_bf16 v[32:47], v[16:19], v[24:27], v[32:47]
    ds_read_b128 v[16:19], v9 offset:43072
    ds_read_b64_tr_b16 v[24:25], v10 offset:49152
    ds_read_b64_tr_b16 v[26:27], v10 offset:49920
    s_waitcnt lgkmcnt(3)
    v_mfma_f32_32x32x16_bf16 v[32:47], v[20:23], v[28:31], v[32:47]
    ds_read_b128 v[20:23], v9 offset:43104
    ds_read_b64_tr_b16 v[28:29], v10 offset:52224
    ds_read_b64_tr_b16 v[30:31], v10 offset:52992
    s_waitcnt lgkmcnt(3)
    v_mfma_f32_32x32x16_bf16 v[32:47], v[16:19], v[24:27], v[32:47]
    s_waitcnt lgkmcnt(0)
    s_barrier
    ds_read_b128 v[16:19], v9 offset:0
    ds_read_b64_tr_b16 v[24:25], v10 offset:0
    ds_read_b64_tr_b16 v[26:27], v10 offset:768
    v_mfma_f32_32x32x16_bf16 v[32:47], v[20:23], v[28:31], v[32:47]
    s_waitcnt vmcnt(4)
    ds_write_b128 v3, v[64:67] offset:21504
    ds_write_b128 v4, v[68:71] offset:21504
    ds_write_b128 v7, v[72:75] offset:30720
    ds_write_b128 v8, v[76:79] offset:30720
    ds_read_b128 v[20:23], v9 offset:32
    ds_read_b64_tr_b16 v[28:29], v10 offset:3072
    ds_read_b64_tr_b16 v[30:31], v10 offset:3840
    s_waitcnt lgkmcnt(7)
    v_mfma_f32_32x32x16_bf16 v[32:47], v[16:19], v[24:27], v[32:47]
    ds_read_b128 v[16:19], v9 offset:64
    ds_read_b64_tr_b16 v[24:25], v10 offset:6144
    ds_read_b64_tr_b16 v[26:27], v10 offset:6912
    s_waitcnt lgkmcnt(3)
    v_mfma_f32_32x32x16_bf16 v[32:47], v[20:23], v[28:31], v[32:47]
    ds_read_b128 v[20:23], v9 offset:96
    ds_read_b64_tr_b16 v[28:29], v10 offset:9216
    ds_read_b64_tr_b16 v[30:31], v10 offset:9984
    s_waitcnt lgkmcnt(3)
    v_mfma_f32_32x32x16_bf16 v[32:47], v[16:19], v[24:27], v[32:47]
    s_waitcnt lgkmcnt(0)
    s_barrier
    ds_read_b128 v[16:19], v9 offset:21504
    ds_read_b64_tr_b16 v[24:25], v10 offset:21504
    ds_read_b64_tr_b16 v[26:27], v10 offset:22272
    v_mfma_f32_32x32x16_bf16 v[32:47], v[20:23], v[28:31], v[32:47]
    s_waitcnt vmcnt(0)
    ds_write_b128 v3, v[80:83] offset:43008
    ds_write_b128 v4, v[84:87] offset:43008
    ds_write_b128 v7, v[88:91] offset:52224
    ds_write_b128 v8, v[92:95] offset:52224
    ds_read_b128 v[20:23], v9 offset:21536
    ds_read_b64_tr_b16 v[28:29], v10 offset:24576
    ds_read_b64_tr_b16 v[30:31], v10 offset:25344
    s_waitcnt lgkmcnt(7)
    v_mfma_f32_32x32x16_bf16 v[32:47], v[16:19], v[24:27], v[32:47]
    ds_read_b128 v[16:19], v9 offset:21568
    ds_read_b64_tr_b16 v[24:25], v10 offset:27648
    ds_read_b64_tr_b16 v[26:27], v10 offset:28416
    s_waitcnt lgkmcnt(3)
    v_mfma_f32_32x32x16_bf16 v[32:47], v[20:23], v[28:31], v[32:47]
    ds_read_b128 v[20:23], v9 offset:21600
    ds_read_b64_tr_b16 v[28:29], v10 offset:30720
    ds_read_b64_tr_b16 v[30:31], v10 offset:31488
    s_waitcnt lgkmcnt(3)
    v_mfma_f32_32x32x16_bf16 v[32:47], v[16:19], v[24:27], v[32:47]
    s_waitcnt lgkmcnt(0)
    s_barrier
    ds_read_b128 v[16:19], v9 offset:43008
    ds_read_b64_tr_b16 v[24:25], v10 offset:43008
    ds_read_b64_tr_b16 v[26:27], v10 offset:43776
    v_mfma_f32_32x32x16_bf16 v[32:47], v[20:23], v[28:31], v[32:47]
    ds_read_b128 v[20:23], v9 offset:43040
    ds_read_b64_tr_b16 v[28:29], v10 offset:46080
    ds_read_b64_tr_b16 v[30:31], v10 offset:46848
    s_waitcnt lgkmcnt(3)
    v_mfma_f32_32x32x16_bf16 v[32:47], v[16:19], v[24:27], v[32:47]
    ds_read_b128 v[16:19], v9 offset:43072
    ds_read_b64_tr_b16 v[24:25], v10 offset:49152
    ds_read_b64_tr_b16 v[26:27], v10 offset:49920
    s_waitcnt lgkmcnt(3)
    v_mfma_f32_32x32x16_bf16 v[32:47], v[20:23], v[28:31], v[32:47]
    ds_read_b128 v[20:23], v9 offset:43104
    ds_read_b64_tr_b16 v[28:29], v10 offset:52224
    ds_read_b64_tr_b16 v[30:31], v10 offset:52992
    s_waitcnt lgkmcnt(3)
    v_mfma_f32_32x32x16_bf16 v[32:47], v[16:19], v[24:27], v[32:47]
    s_waitcnt lgkmcnt(0)
    v_mfma_f32_32x32x16_bf16 v[32:47], v[20:23], v[28:31], v[32:47]
    s_nop 11
    v_cvt_pk_bf16_f32 v32, v32, v32
    v_sub_f32 v11, 1.0, v96
    v_and_b32 v32, 0xffff0000, v32
    v_lshlrev_b32 v12, 16, v112
    v_cvt_pk_bf16_f32 v11, v11, v11
    v_mul_f32 v32, v96, v32
    v_and_b32 v11, 0xffff0000, v11
    v_mul_f32 v11, v11, v12
    v_cvt_pk_bf16_f32 v32, v32, v11
    v_lshlrev_b32 v11, 16, v32
    v_and_b32 v32, 0xffff0000, v32
    v_add_f32 v32, v32, v11
    v_cvt_pk_bf16_f32 v32, v32, v32
    s_mov_b32 s29, 0x0
    buffer_store_short v32, v120, s[12:15], s29 offen
    v_cvt_pk_bf16_f32 v33, v33, v33
    v_sub_f32 v11, 1.0, v97
    v_and_b32 v33, 0xffff0000, v33
    v_and_b32 v12, 0xffff0000, v112
    v_cvt_pk_bf16_f32 v11, v11, v11
    v_mul_f32 v33, v97, v33
    v_and_b32 v11, 0xffff0000, v11
    v_mul_f32 v11, v11, v12
    v_cvt_pk_bf16_f32 v33, v33, v11
    v_lshlrev_b32 v11, 16, v33
    v_and_b32 v33, 0xffff0000, v33
    v_add_f32 v33, v33, v11
    v_cvt_pk_bf16_f32 v33, v33, v33
    s_mov_b32 s29, 0x480
    buffer_store_short v33, v120, s[12:15], s29 offen
    v_cvt_pk_bf16_f32 v34, v34, v34
    v_sub_f32 v11, 1.0, v98
    v_and_b32 v34, 0xffff0000, v34
    v_lshlrev_b32 v12, 16, v113
    v_cvt_pk_bf16_f32 v11, v11, v11
    v_mul_f32 v34, v98, v34
    v_and_b32 v11, 0xffff0000, v11
    v_mul_f32 v11, v11, v12
    v_cvt_pk_bf16_f32 v34, v34, v11
    v_lshlrev_b32 v11, 16, v34
    v_and_b32 v34, 0xffff0000, v34
    v_add_f32 v34, v34, v11
    v_cvt_pk_bf16_f32 v34, v34, v34
    s_mov_b32 s29, 0x900
    buffer_store_short v34, v120, s[12:15], s29 offen
    v_cvt_pk_bf16_f32 v35, v35, v35
    v_sub_f32 v11, 1.0, v99
    v_and_b32 v35, 0xffff0000, v35
    v_and_b32 v12, 0xffff0000, v113
    v_cvt_pk_bf16_f32 v11, v11, v11
    v_mul_f32 v35, v99, v35
    v_and_b32 v11, 0xffff0000, v11
    v_mul_f32 v11, v11, v12
    v_cvt_pk_bf16_f32 v35, v35, v11
    v_lshlrev_b32 v11, 16, v35
    v_and_b32 v35, 0xffff0000, v35
    v_add_f32 v35, v35, v11
    v_cvt_pk_bf16_f32 v35, v35, v35
    s_mov_b32 s29, 0xd80
    buffer_store_short v35, v120, s[12:15], s29 offen
    v_cvt_pk_bf16_f32 v36, v36, v36
    v_sub_f32 v11, 1.0, v100
    v_and_b32 v36, 0xffff0000, v36
    v_lshlrev_b32 v12, 16, v114
    v_cvt_pk_bf16_f32 v11, v11, v11
    v_mul_f32 v36, v100, v36
    v_and_b32 v11, 0xffff0000, v11
    v_mul_f32 v11, v11, v12
    v_cvt_pk_bf16_f32 v36, v36, v11
    v_lshlrev_b32 v11, 16, v36
    v_and_b32 v36, 0xffff0000, v36
    v_add_f32 v36, v36, v11
    v_cvt_pk_bf16_f32 v36, v36, v36
    s_mov_b32 s29, 0x2400
    buffer_store_short v36, v120, s[12:15], s29 offen
    v_cvt_pk_bf16_f32 v37, v37, v37
    v_sub_f32 v11, 1.0, v101
    v_and_b32 v37, 0xffff0000, v37
    v_and_b32 v12, 0xffff0000, v114
    v_cvt_pk_bf16_f32 v11, v11, v11
    v_mul_f32 v37, v101, v37
    v_and_b32 v11, 0xffff0000, v11
    v_mul_f32 v11, v11, v12
    v_cvt_pk_bf16_f32 v37, v37, v11
    v_lshlrev_b32 v11, 16, v37
    v_and_b32 v37, 0xffff0000, v37
    v_add_f32 v37, v37, v11
    v_cvt_pk_bf16_f32 v37, v37, v37
    s_mov_b32 s29, 0x2880
    buffer_store_short v37, v120, s[12:15], s29 offen
    v_cvt_pk_bf16_f32 v38, v38, v38
    v_sub_f32 v11, 1.0, v102
    v_and_b32 v38, 0xffff0000, v38
    v_lshlrev_b32 v12, 16, v115
    v_cvt_pk_bf16_f32 v11, v11, v11
    v_mul_f32 v38, v102, v38
    v_and_b32 v11, 0xffff0000, v11
    v_mul_f32 v11, v11, v12
    v_cvt_pk_bf16_f32 v38, v38, v11
    v_lshlrev_b32 v11, 16, v38
    v_and_b32 v38, 0xffff0000, v38
    v_add_f32 v38, v38, v11
    v_cvt_pk_bf16_f32 v38, v38, v38
    s_mov_b32 s29, 0x2d00
    buffer_store_short v38, v120, s[12:15], s29 offen
    v_cvt_pk_bf16_f32 v39, v39, v39
    v_sub_f32 v11, 1.0, v103
    v_and_b32 v39, 0xffff0000, v39
    v_and_b32 v12, 0xffff0000, v115
    v_cvt_pk_bf16_f32 v11, v11, v11
    v_mul_f32 v39, v103, v39
    v_and_b32 v11, 0xffff0000, v11
    v_mul_f32 v11, v11, v12
    v_cvt_pk_bf16_f32 v39, v39, v11
    v_lshlrev_b32 v11, 16, v39
    v_and_b32 v39, 0xffff0000, v39
    v_add_f32 v39, v39, v11
    v_cvt_pk_bf16_f32 v39, v39, v39
    s_mov_b32 s29, 0x3180
    buffer_store_short v39, v120, s[12:15], s29 offen
    v_cvt_pk_bf16_f32 v40, v40, v40
    v_sub_f32 v11, 1.0, v104
    v_and_b32 v40, 0xffff0000, v40
    v_lshlrev_b32 v12, 16, v116
    v_cvt_pk_bf16_f32 v11, v11, v11
    v_mul_f32 v40, v104, v40
    v_and_b32 v11, 0xffff0000, v11
    v_mul_f32 v11, v11, v12
    v_cvt_pk_bf16_f32 v40, v40, v11
    v_lshlrev_b32 v11, 16, v40
    v_and_b32 v40, 0xffff0000, v40
    v_add_f32 v40, v40, v11
    v_cvt_pk_bf16_f32 v40, v40, v40
    s_mov_b32 s29, 0x4800
    buffer_store_short v40, v120, s[12:15], s29 offen
    v_cvt_pk_bf16_f32 v41, v41, v41
    v_sub_f32 v11, 1.0, v105
    v_and_b32 v41, 0xffff0000, v41
    v_and_b32 v12, 0xffff0000, v116
    v_cvt_pk_bf16_f32 v11, v11, v11
    v_mul_f32 v41, v105, v41
    v_and_b32 v11, 0xffff0000, v11
    v_mul_f32 v11, v11, v12
    v_cvt_pk_bf16_f32 v41, v41, v11
    v_lshlrev_b32 v11, 16, v41
    v_and_b32 v41, 0xffff0000, v41
    v_add_f32 v41, v41, v11
    v_cvt_pk_bf16_f32 v41, v41, v41
    s_mov_b32 s29, 0x4c80
    buffer_store_short v41, v120, s[12:15], s29 offen
    v_cvt_pk_bf16_f32 v42, v42, v42
    v_sub_f32 v11, 1.0, v106
    v_and_b32 v42, 0xffff0000, v42
    v_lshlrev_b32 v12, 16, v117
    v_cvt_pk_bf16_f32 v11, v11, v11
    v_mul_f32 v42, v106, v42
    v_and_b32 v11, 0xffff0000, v11
    v_mul_f32 v11, v11, v12
    v_cvt_pk_bf16_f32 v42, v42, v11
    v_lshlrev_b32 v11, 16, v42
    v_and_b32 v42, 0xffff0000, v42
    v_add_f32 v42, v42, v11
    v_cvt_pk_bf16_f32 v42, v42, v42
    s_mov_b32 s29, 0x5100
    buffer_store_short v42, v120, s[12:15], s29 offen
    v_cvt_pk_bf16_f32 v43, v43, v43
    v_sub_f32 v11, 1.0, v107
    v_and_b32 v43, 0xffff0000, v43
    v_and_b32 v12, 0xffff0000, v117
    v_cvt_pk_bf16_f32 v11, v11, v11
    v_mul_f32 v43, v107, v43
    v_and_b32 v11, 0xffff0000, v11
    v_mul_f32 v11, v11, v12
    v_cvt_pk_bf16_f32 v43, v43, v11
    v_lshlrev_b32 v11, 16, v43
    v_and_b32 v43, 0xffff0000, v43
    v_add_f32 v43, v43, v11
    v_cvt_pk_bf16_f32 v43, v43, v43
    s_mov_b32 s29, 0x5580
    buffer_store_short v43, v120, s[12:15], s29 offen
    v_cvt_pk_bf16_f32 v44, v44, v44
    v_sub_f32 v11, 1.0, v108
    v_and_b32 v44, 0xffff0000, v44
    v_lshlrev_b32 v12, 16, v118
    v_cvt_pk_bf16_f32 v11, v11, v11
    v_mul_f32 v44, v108, v44
    v_and_b32 v11, 0xffff0000, v11
    v_mul_f32 v11, v11, v12
    v_cvt_pk_bf16_f32 v44, v44, v11
    v_lshlrev_b32 v11, 16, v44
    v_and_b32 v44, 0xffff0000, v44
    v_add_f32 v44, v44, v11
    v_cvt_pk_bf16_f32 v44, v44, v44
    s_mov_b32 s29, 0x6c00
    buffer_store_short v44, v120, s[12:15], s29 offen
    v_cvt_pk_bf16_f32 v45, v45, v45
    v_sub_f32 v11, 1.0, v109
    v_and_b32 v45, 0xffff0000, v45
    v_and_b32 v12, 0xffff0000, v118
    v_cvt_pk_bf16_f32 v11, v11, v11
    v_mul_f32 v45, v109, v45
    v_and_b32 v11, 0xffff0000, v11
    v_mul_f32 v11, v11, v12
    v_cvt_pk_bf16_f32 v45, v45, v11
    v_lshlrev_b32 v11, 16, v45
    v_and_b32 v45, 0xffff0000, v45
    v_add_f32 v45, v45, v11
    v_cvt_pk_bf16_f32 v45, v45, v45
    s_mov_b32 s29, 0x7080
    buffer_store_short v45, v120, s[12:15], s29 offen
    v_cvt_pk_bf16_f32 v46, v46, v46
    v_sub_f32 v11, 1.0, v110
    v_and_b32 v46, 0xffff0000, v46
    v_lshlrev_b32 v12, 16, v119
    v_cvt_pk_bf16_f32 v11, v11, v11
    v_mul_f32 v46, v110, v46
    v_and_b32 v11, 0xffff0000, v11
    v_mul_f32 v11, v11, v12
    v_cvt_pk_bf16_f32 v46, v46, v11
    v_lshlrev_b32 v11, 16, v46
    v_and_b32 v46, 0xffff0000, v46
    v_add_f32 v46, v46, v11
    v_cvt_pk_bf16_f32 v46, v46, v46
    s_mov_b32 s29, 0x7500
    buffer_store_short v46, v120, s[12:15], s29 offen
    v_cvt_pk_bf16_f32 v47, v47, v47
    v_sub_f32 v11, 1.0, v111
    v_and_b32 v47, 0xffff0000, v47
    v_and_b32 v12, 0xffff0000, v119
    v_cvt_pk_bf16_f32 v11, v11, v11
    v_mul_f32 v47, v111, v47
    v_and_b32 v11, 0xffff0000, v11
    v_mul_f32 v11, v11, v12
    v_cvt_pk_bf16_f32 v47, v47, v11
    v_lshlrev_b32 v11, 16, v47
    v_and_b32 v47, 0xffff0000, v47
    v_add_f32 v47, v47, v11
    v_cvt_pk_bf16_f32 v47, v47, v47
    s_mov_b32 s29, 0x7980
    buffer_store_short v47, v120, s[12:15], s29 offen
    s_waitcnt vmcnt(0)
END_18:
    s_endpgm
.section .rodata,"a"
.p2align 6
.amdhsa_kernel l1_kernel
  .amdhsa_next_free_vgpr 176
  .amdhsa_next_free_sgpr 102
  .amdhsa_accum_offset 176
  .amdhsa_group_segment_fixed_size 0
  .amdhsa_kernarg_size 112
  .amdhsa_user_sgpr_count 2
  .amdhsa_user_sgpr_kernarg_segment_ptr 1
  .amdhsa_system_sgpr_workgroup_id_x 1
.end_amdhsa_kernel
.p2align 6
.amdhsa_kernel l2_kernel
  .amdhsa_next_free_vgpr 192
  .amdhsa_next_free_sgpr 102
  .amdhsa_accum_offset 192
  .amdhsa_group_segment_fixed_size 0
  .amdhsa_kernarg_size 112
  .amdhsa_user_sgpr_count 2
  .amdhsa_user_sgpr_kernarg_segment_ptr 1
  .amdhsa_system_sgpr_workgroup_id_x 1
.end_amdhsa_kernel
.p2align 6
.amdhsa_kernel l3_kernel
  .amdhsa_next_free_vgpr 124
  .amdhsa_next_free_sgpr 102
  .amdhsa_accum_offset 124
  .amdhsa_group_segment_fixed_size 0
  .amdhsa_kernarg_size 112
  .amdhsa_user_sgpr_count 2
  .amdhsa_user_sgpr_kernarg_segment_ptr 1
  .amdhsa_system_sgpr_workgroup_id_x 1
.end_amdhsa_kernel
```
